```python
import torch

def _softmax(x, axis=-1):
    return torch.softmax(x, dim=axis)
def _gelu(x):
    return torch.nn.functional.gelu(x, approximate="tanh")
def _silu(x):
    return torch.nn.functional.silu(x)
def _sigmoid(x):
    return torch.sigmoid(x)
def _layernorm(x, axis=-1, eps=1e-5):
    m = x.mean(dim=axis, keepdim=True)
    v = x.var(dim=axis, keepdim=True, unbiased=False)
    return (x - m) / torch.sqrt(v + eps)
def _scatter_add(tgt, idx, src, axis=0):
    return tgt.clone().index_add_(axis, idx, src)
def _segment_sum(src, seg, n):
    out = torch.zeros((n,) + src.shape[1:], dtype=src.dtype)
    return out.index_add_(0, seg, src)
def _pad(x, pw):
    flat = tuple(v for pair in reversed(pw) for v in pair)
    return torch.nn.functional.pad(x, flat)

kernel_name = 'sequential_preLN__sliding_block__dense_activation_relu__prompt'

def setup_inputs():

    _w = (lambda a: (lambda t: t.to(torch.bfloat16) if t.is_floating_point() else t)(torch.as_tensor(a)))
    def _A_setup():
        B, S, D = 1, 2048, 512
        return {
            "x": _w((lambda *s: torch.randn(*s, dtype=torch.bfloat16) * 0.05)(B, S, D)),
            "wqkv": _w((lambda *s: torch.randn(*s, dtype=torch.bfloat16) * 0.05)(D, 3 * D)),
            "wo": _w((lambda *s: torch.randn(*s, dtype=torch.bfloat16) * 0.05)(D, D)),
        }
    _A_in = _A_setup()

    def _B_setup():
        B, S, D, Dff = 1, 2048, 512, 1376
        return {
            "x": _w((lambda *s: torch.randn(*s, dtype=torch.bfloat16) * 0.05)(B, S, D)),
            "w1": _w((lambda *s: torch.randn(*s, dtype=torch.bfloat16) * 0.05)(D, Dff)),
            "w2": _w((lambda *s: torch.randn(*s, dtype=torch.bfloat16) * 0.05)(Dff, D)),
        }
    _B_in = _B_setup()

    return {
        "A_x": _A_in["x"],
        "A_wqkv": _A_in["wqkv"],
        "A_wo": _A_in["wo"],
        "B_x": _B_in["x"],
        "B_w1": _B_in["w1"],
        "B_w2": _B_in["w2"],
    }

def reference(A_x, A_wqkv, A_wo, B_x, B_w1, B_w2):
    def _A_ref(x, wqkv, wo):
        B, S, D = x.shape
        H = 32; Dh = D // H; W = 256
        qkv = (lambda x, *d: x.permute(*d))((x @ wqkv).reshape(B, S, 3, H, Dh), 2, 0, 3, 1, 4)
        q, k, v = qkv[0], qkv[1], qkv[2]
        scores = torch.einsum("bhqd,bhkd->bhqk", q, k) * (Dh ** -0.5)
        idx = torch.arange(S)
        mask = (idx[:, None] - idx[None, :] >= 0) & (idx[:, None] - idx[None, :] < W)
        scores = torch.where(mask[None, None], scores, -1e9)
        p = _softmax(scores, axis=-1)
        o = torch.einsum("bhqk,bhkd->bhqd", p, v)
        return (lambda x, *d: x.permute(*d))(o, 0, 2, 1, 3).reshape(B, S, D) @ wo

    def _B_ref(x, w1, w2):
        h = torch.einsum("bsd,df->bsf", x, w1)
        zero = torch.zeros_like(h)
        h = torch.maximum(h, zero)
        return torch.einsum("bsf,fd->bsd", h, w2)

    x = A_x
    h = x + _A_ref(_layernorm(x, axis=-1), A_wqkv, A_wo)
    h2 = h + _B_ref(_layernorm(h, axis=-1), B_w1, B_w2)
    return h2
```

```asm
; @launch kernel=kqkv_kernel grid=(256,1,1) block=(768,1,1) lds=136192
; @launch kernel=kattn_kernel grid=(256,1,1) block=(512,1,1) lds=43008
; @launch kernel=kwo_kernel grid=(256,1,1) block=(768,1,1) lds=136192
; @launch kernel=kw1_kernel grid=(240,1,1) block=(768,1,1) lds=136192
; @launch kernel=kw2_kernel grid=(256,1,1) block=(768,1,1) lds=136192
.amdgcn_target "amdgcn-amd-amdhsa--gfx950"
.text
.globl kqkv_kernel
.p2align 8
.type kqkv_kernel,@function
kqkv_kernel:
    s_cmp_ge_u32 s2, 256
    s_cbranch_scc1 L_kqkv_kernel_end
    s_load_dwordx2 s[4:5], s[0:1], 0
    s_load_dwordx2 s[6:7], s[0:1], 8
    s_load_dwordx4 s[8:11], s[0:1], 56
    s_load_dwordx2 s[54:55], s[0:1], 48
    s_and_b32 s24, s2, 7
    s_lshr_b32 s25, s2, 3
    s_and_b32 s26, s25, 1
    s_lshl_b32 s24, s24, 1
    s_add_u32 s24, s24, s26
    s_lshr_b32 s25, s25, 1
    s_lshl_b32 s50, s24, 2
    v_and_b32 v1, 63, v0
    v_lshrrev_b32 v9, 6, v0
    s_nop 0
    v_readfirstlane_b32 s26, v9
    v_lshrrev_b32 v13, 5, v1
    s_and_b32 s48, s26, 3
    s_lshr_b32 s57, s26, 2
    s_cmp_ge_u32 s26, 8
    s_cbranch_scc1 L_kqkv_kernel_compute
    v_lshrrev_b32 v9, 4, v1
    v_and_b32 v10, 15, v1
    v_lshlrev_b32 v11, 2, v9
    v_xor_b32 v10, v10, v11
    s_mov_b32 s36, 3072
    v_mul_lo_u32 v3, v9, s36
    s_lshl_b32 s36, s25, 7
    s_lshl_b32 s37, s25, 6
    s_add_u32 s37, s37, 2048
    v_lshlrev_b32 v11, 4, v10
    v_add_u32 v11, s36, v11
    v_and_b32 v12, 3, v10
    v_lshlrev_b32 v12, 4, v12
    v_add_u32 v12, s37, v12
    v_cmp_gt_u32 vcc, 8, v10
    s_nop 1
    v_cndmask_b32 v11, v12, v11, vcc
    v_add_u32 v3, v3, v11
    v_cmp_gt_u32 vcc, 12, v10
    s_mov_b64 s[38:39], vcc
    v_lshrrev_b32 v9, 3, v1
    v_lshrrev_b32 v10, 4, v1
    v_and_b32 v11, 7, v1
    v_xor_b32 v12, v11, v10
    v_lshlrev_b32 v12, 4, v12
    v_lshlrev_b32 v2, 10, v9
    v_add_u32 v15, 4, v10
    v_xor_b32 v15, v11, v15
    v_lshlrev_b32 v15, 4, v15
    v_add_u32 v15, v15, v2
    v_add_u32 v2, v2, v12
    s_lshl_b32 s51, s24, 17
    s_lshl_b32 s52, s48, 15
    s_add_u32 s51, s51, s52
    s_lshl_b32 s53, s48, 12
    s_mul_i32 s43, s48, 49152
    s_waitcnt lgkmcnt(0)
    s_mov_b32 s16, s6
    s_and_b32 s17, s7, 0xffff
    s_mov_b32 s18, 1572864
    s_mov_b32 s19, 0x00020000
    s_mov_b32 s12, s4
    s_and_b32 s13, s5, 0xffff
    s_mov_b32 s14, 2097152
    s_mov_b32 s15, 0x00020000
    s_lshl_b32 s58, s57, 11
    s_add_u32 s53, s53, s58
    s_lshl_b32 s59, s57, 14
    s_add_u32 s51, s51, s59
    s_mul_i32 s59, s57, 24576
    s_add_u32 s43, s43, s59
    v_lshrrev_b32 v9, 2, v1
    v_and_b32 v9, 3, v9
    v_lshlrev_b32 v10, 3, v13
    v_add_u32 v10, v10, v9
    v_lshlrev_b32 v10, 8, v10
    v_lshrrev_b32 v11, 4, v1
    v_and_b32 v11, 1, v11
    v_lshlrev_b32 v11, 5, v11
    v_and_b32 v12, 3, v1
    v_lshlrev_b32 v12, 3, v12
    v_add_u32 v10, v10, v11
    v_add_u32 v10, v10, v12
    s_lshl_b32 s36, s48, 12
    v_add_u32 v10, s36, v10
    v_xor_b32 v11, 0, v9
    v_lshlrev_b32 v11, 6, v11
    v_add_u32 v40, v10, v11
    v_add_u32 v43, 65536, v40
    v_mov_b32 v6, 0
    v_xor_b32 v11, 1, v9
    v_lshlrev_b32 v11, 6, v11
    v_add_u32 v41, v10, v11
    v_add_u32 v44, 65536, v41
    v_mov_b32 v7, 0
    v_xor_b32 v11, 2, v9
    v_lshlrev_b32 v11, 6, v11
    v_add_u32 v42, v10, v11
    v_add_u32 v45, 65536, v42
    v_mov_b32 v8, 0
    s_mov_b32 s40, 0x3f803f80
    s_add_u32 s44, s53, 0
    s_mov_b32 m0, s44
    s_add_u32 s45, s51, 0
    buffer_load_dwordx4 v2, s[12:15], s45 offen lds
    s_add_u32 s44, s53, 1024
    s_mov_b32 m0, s44
    s_add_u32 s45, s51, 8192
    buffer_load_dwordx4 v15, s[12:15], s45 offen lds
    s_mov_b64 exec, s[38:39]
    s_add_u32 s44, s53, 16384
    s_mov_b32 m0, s44
    s_add_u32 s45, s43, 0
    buffer_load_dwordx4 v3, s[16:19], s45 offen lds
    s_add_u32 s44, s53, 17408
    s_mov_b32 m0, s44
    s_add_u32 s45, s43, 12288
    buffer_load_dwordx4 v3, s[16:19], s45 offen lds
    s_mov_b64 exec, -1
    s_barrier
    s_add_u32 s44, s53, 32768
    s_mov_b32 m0, s44
    s_add_u32 s45, s51, 128
    buffer_load_dwordx4 v2, s[12:15], s45 offen lds
    s_add_u32 s44, s53, 33792
    s_mov_b32 m0, s44
    s_add_u32 s45, s51, 8320
    buffer_load_dwordx4 v15, s[12:15], s45 offen lds
    s_mov_b64 exec, s[38:39]
    s_add_u32 s44, s53, 49152
    s_mov_b32 m0, s44
    s_add_u32 s45, s43, 196608
    buffer_load_dwordx4 v3, s[16:19], s45 offen lds
    s_add_u32 s44, s53, 50176
    s_mov_b32 m0, s44
    s_add_u32 s45, s43, 208896
    buffer_load_dwordx4 v3, s[16:19], s45 offen lds
    s_mov_b64 exec, -1
    s_barrier
    s_add_u32 s44, s53, 65536
    s_mov_b32 m0, s44
    s_add_u32 s45, s51, 256
    buffer_load_dwordx4 v2, s[12:15], s45 offen lds
    s_add_u32 s44, s53, 66560
    s_mov_b32 m0, s44
    s_add_u32 s45, s51, 8448
    buffer_load_dwordx4 v15, s[12:15], s45 offen lds
    s_mov_b64 exec, s[38:39]
    s_add_u32 s44, s53, 81920
    s_mov_b32 m0, s44
    s_add_u32 s45, s43, 393216
    buffer_load_dwordx4 v3, s[16:19], s45 offen lds
    s_add_u32 s44, s53, 82944
    s_mov_b32 m0, s44
    s_add_u32 s45, s43, 405504
    buffer_load_dwordx4 v3, s[16:19], s45 offen lds
    s_mov_b64 exec, -1
    s_waitcnt vmcnt(8)
    s_barrier
    s_add_u32 s44, s53, 98304
    s_mov_b32 m0, s44
    s_add_u32 s45, s51, 384
    buffer_load_dwordx4 v2, s[12:15], s45 offen lds
    s_add_u32 s44, s53, 99328
    s_mov_b32 m0, s44
    s_add_u32 s45, s51, 8576
    buffer_load_dwordx4 v15, s[12:15], s45 offen lds
    s_mov_b64 exec, s[38:39]
    s_add_u32 s44, s53, 114688
    s_mov_b32 m0, s44
    s_add_u32 s45, s43, 589824
    buffer_load_dwordx4 v3, s[16:19], s45 offen lds
    s_add_u32 s44, s53, 115712
    s_mov_b32 m0, s44
    s_add_u32 s45, s43, 602112
    buffer_load_dwordx4 v3, s[16:19], s45 offen lds
    s_mov_b64 exec, -1
    s_cmp_lg_u32 s57, 0
    s_cbranch_scc1 L_kqkv_kernel_nocs0
    ds_read_b64_tr_b16 v[16:17], v40 offset:16384
    ds_read_b64_tr_b16 v[18:19], v40 offset:17408
    ds_read_b64_tr_b16 v[20:21], v41 offset:16384
    ds_read_b64_tr_b16 v[22:23], v41 offset:17408
    ds_read_b64_tr_b16 v[24:25], v42 offset:16384
    ds_read_b64_tr_b16 v[26:27], v42 offset:17408
    s_waitcnt lgkmcnt(0)
    v_dot2_f32_bf16 v6, v16, s40, v6
    v_dot2_f32_bf16 v6, v17, s40, v6
    v_dot2_f32_bf16 v6, v18, s40, v6
    v_dot2_f32_bf16 v6, v19, s40, v6
    v_dot2_f32_bf16 v7, v20, s40, v7
    v_dot2_f32_bf16 v7, v21, s40, v7
    v_dot2_f32_bf16 v7, v22, s40, v7
    v_dot2_f32_bf16 v7, v23, s40, v7
    v_dot2_f32_bf16 v8, v24, s40, v8
    v_dot2_f32_bf16 v8, v25, s40, v8
    v_dot2_f32_bf16 v8, v26, s40, v8
    v_dot2_f32_bf16 v8, v27, s40, v8
L_kqkv_kernel_nocs0:
    s_waitcnt vmcnt(8)
    s_barrier
    s_add_u32 s44, s53, 0
    s_mov_b32 m0, s44
    s_add_u32 s45, s51, 512
    buffer_load_dwordx4 v2, s[12:15], s45 offen lds
    s_add_u32 s44, s53, 1024
    s_mov_b32 m0, s44
    s_add_u32 s45, s51, 8704
    buffer_load_dwordx4 v15, s[12:15], s45 offen lds
    s_mov_b64 exec, s[38:39]
    s_add_u32 s44, s53, 16384
    s_mov_b32 m0, s44
    s_add_u32 s45, s43, 786432
    buffer_load_dwordx4 v3, s[16:19], s45 offen lds
    s_add_u32 s44, s53, 17408
    s_mov_b32 m0, s44
    s_add_u32 s45, s43, 798720
    buffer_load_dwordx4 v3, s[16:19], s45 offen lds
    s_mov_b64 exec, -1
    s_cmp_lg_u32 s57, 1
    s_cbranch_scc1 L_kqkv_kernel_nocs1
    ds_read_b64_tr_b16 v[16:17], v40 offset:49152
    ds_read_b64_tr_b16 v[18:19], v40 offset:50176
    ds_read_b64_tr_b16 v[20:21], v41 offset:49152
    ds_read_b64_tr_b16 v[22:23], v41 offset:50176
    ds_read_b64_tr_b16 v[24:25], v42 offset:49152
    ds_read_b64_tr_b16 v[26:27], v42 offset:50176
    s_waitcnt lgkmcnt(0)
    v_dot2_f32_bf16 v6, v16, s40, v6
    v_dot2_f32_bf16 v6, v17, s40, v6
    v_dot2_f32_bf16 v6, v18, s40, v6
    v_dot2_f32_bf16 v6, v19, s40, v6
    v_dot2_f32_bf16 v7, v20, s40, v7
    v_dot2_f32_bf16 v7, v21, s40, v7
    v_dot2_f32_bf16 v7, v22, s40, v7
    v_dot2_f32_bf16 v7, v23, s40, v7
    v_dot2_f32_bf16 v8, v24, s40, v8
    v_dot2_f32_bf16 v8, v25, s40, v8
    v_dot2_f32_bf16 v8, v26, s40, v8
    v_dot2_f32_bf16 v8, v27, s40, v8
L_kqkv_kernel_nocs1:
    s_waitcnt vmcnt(8)
    s_barrier
    s_add_u32 s44, s53, 32768
    s_mov_b32 m0, s44
    s_add_u32 s45, s51, 640
    buffer_load_dwordx4 v2, s[12:15], s45 offen lds
    s_add_u32 s44, s53, 33792
    s_mov_b32 m0, s44
    s_add_u32 s45, s51, 8832
    buffer_load_dwordx4 v15, s[12:15], s45 offen lds
    s_mov_b64 exec, s[38:39]
    s_add_u32 s44, s53, 49152
    s_mov_b32 m0, s44
    s_add_u32 s45, s43, 983040
    buffer_load_dwordx4 v3, s[16:19], s45 offen lds
    s_add_u32 s44, s53, 50176
    s_mov_b32 m0, s44
    s_add_u32 s45, s43, 995328
    buffer_load_dwordx4 v3, s[16:19], s45 offen lds
    s_mov_b64 exec, -1
    s_cmp_lg_u32 s57, 0
    s_cbranch_scc1 L_kqkv_kernel_nocs2
    ds_read_b64_tr_b16 v[16:17], v43 offset:16384
    ds_read_b64_tr_b16 v[18:19], v43 offset:17408
    ds_read_b64_tr_b16 v[20:21], v44 offset:16384
    ds_read_b64_tr_b16 v[22:23], v44 offset:17408
    ds_read_b64_tr_b16 v[24:25], v45 offset:16384
    ds_read_b64_tr_b16 v[26:27], v45 offset:17408
    s_waitcnt lgkmcnt(0)
    v_dot2_f32_bf16 v6, v16, s40, v6
    v_dot2_f32_bf16 v6, v17, s40, v6
    v_dot2_f32_bf16 v6, v18, s40, v6
    v_dot2_f32_bf16 v6, v19, s40, v6
    v_dot2_f32_bf16 v7, v20, s40, v7
    v_dot2_f32_bf16 v7, v21, s40, v7
    v_dot2_f32_bf16 v7, v22, s40, v7
    v_dot2_f32_bf16 v7, v23, s40, v7
    v_dot2_f32_bf16 v8, v24, s40, v8
    v_dot2_f32_bf16 v8, v25, s40, v8
    v_dot2_f32_bf16 v8, v26, s40, v8
    v_dot2_f32_bf16 v8, v27, s40, v8
L_kqkv_kernel_nocs2:
    s_waitcnt vmcnt(8)
    s_barrier
    s_add_u32 s44, s53, 65536
    s_mov_b32 m0, s44
    s_add_u32 s45, s51, 768
    buffer_load_dwordx4 v2, s[12:15], s45 offen lds
    s_add_u32 s44, s53, 66560
    s_mov_b32 m0, s44
    s_add_u32 s45, s51, 8960
    buffer_load_dwordx4 v15, s[12:15], s45 offen lds
    s_mov_b64 exec, s[38:39]
    s_add_u32 s44, s53, 81920
    s_mov_b32 m0, s44
    s_add_u32 s45, s43, 1179648
    buffer_load_dwordx4 v3, s[16:19], s45 offen lds
    s_add_u32 s44, s53, 82944
    s_mov_b32 m0, s44
    s_add_u32 s45, s43, 1191936
    buffer_load_dwordx4 v3, s[16:19], s45 offen lds
    s_mov_b64 exec, -1
    s_cmp_lg_u32 s57, 1
    s_cbranch_scc1 L_kqkv_kernel_nocs3
    ds_read_b64_tr_b16 v[16:17], v43 offset:49152
    ds_read_b64_tr_b16 v[18:19], v43 offset:50176
    ds_read_b64_tr_b16 v[20:21], v44 offset:49152
    ds_read_b64_tr_b16 v[22:23], v44 offset:50176
    ds_read_b64_tr_b16 v[24:25], v45 offset:49152
    ds_read_b64_tr_b16 v[26:27], v45 offset:50176
    s_waitcnt lgkmcnt(0)
    v_dot2_f32_bf16 v6, v16, s40, v6
    v_dot2_f32_bf16 v6, v17, s40, v6
    v_dot2_f32_bf16 v6, v18, s40, v6
    v_dot2_f32_bf16 v6, v19, s40, v6
    v_dot2_f32_bf16 v7, v20, s40, v7
    v_dot2_f32_bf16 v7, v21, s40, v7
    v_dot2_f32_bf16 v7, v22, s40, v7
    v_dot2_f32_bf16 v7, v23, s40, v7
    v_dot2_f32_bf16 v8, v24, s40, v8
    v_dot2_f32_bf16 v8, v25, s40, v8
    v_dot2_f32_bf16 v8, v26, s40, v8
    v_dot2_f32_bf16 v8, v27, s40, v8
L_kqkv_kernel_nocs3:
    s_waitcnt vmcnt(8)
    s_barrier
    s_add_u32 s44, s53, 98304
    s_mov_b32 m0, s44
    s_add_u32 s45, s51, 896
    buffer_load_dwordx4 v2, s[12:15], s45 offen lds
    s_add_u32 s44, s53, 99328
    s_mov_b32 m0, s44
    s_add_u32 s45, s51, 9088
    buffer_load_dwordx4 v15, s[12:15], s45 offen lds
    s_mov_b64 exec, s[38:39]
    s_add_u32 s44, s53, 114688
    s_mov_b32 m0, s44
    s_add_u32 s45, s43, 1376256
    buffer_load_dwordx4 v3, s[16:19], s45 offen lds
    s_add_u32 s44, s53, 115712
    s_mov_b32 m0, s44
    s_add_u32 s45, s43, 1388544
    buffer_load_dwordx4 v3, s[16:19], s45 offen lds
    s_mov_b64 exec, -1
    s_cmp_lg_u32 s57, 0
    s_cbranch_scc1 L_kqkv_kernel_nocs4
    ds_read_b64_tr_b16 v[16:17], v40 offset:16384
    ds_read_b64_tr_b16 v[18:19], v40 offset:17408
    ds_read_b64_tr_b16 v[20:21], v41 offset:16384
    ds_read_b64_tr_b16 v[22:23], v41 offset:17408
    ds_read_b64_tr_b16 v[24:25], v42 offset:16384
    ds_read_b64_tr_b16 v[26:27], v42 offset:17408
    s_waitcnt lgkmcnt(0)
    v_dot2_f32_bf16 v6, v16, s40, v6
    v_dot2_f32_bf16 v6, v17, s40, v6
    v_dot2_f32_bf16 v6, v18, s40, v6
    v_dot2_f32_bf16 v6, v19, s40, v6
    v_dot2_f32_bf16 v7, v20, s40, v7
    v_dot2_f32_bf16 v7, v21, s40, v7
    v_dot2_f32_bf16 v7, v22, s40, v7
    v_dot2_f32_bf16 v7, v23, s40, v7
    v_dot2_f32_bf16 v8, v24, s40, v8
    v_dot2_f32_bf16 v8, v25, s40, v8
    v_dot2_f32_bf16 v8, v26, s40, v8
    v_dot2_f32_bf16 v8, v27, s40, v8
L_kqkv_kernel_nocs4:
    s_waitcnt vmcnt(8)
    s_barrier
    s_cmp_lg_u32 s57, 1
    s_cbranch_scc1 L_kqkv_kernel_nocs5
    ds_read_b64_tr_b16 v[16:17], v40 offset:49152
    ds_read_b64_tr_b16 v[18:19], v40 offset:50176
    ds_read_b64_tr_b16 v[20:21], v41 offset:49152
    ds_read_b64_tr_b16 v[22:23], v41 offset:50176
    ds_read_b64_tr_b16 v[24:25], v42 offset:49152
    ds_read_b64_tr_b16 v[26:27], v42 offset:50176
    s_waitcnt lgkmcnt(0)
    v_dot2_f32_bf16 v6, v16, s40, v6
    v_dot2_f32_bf16 v6, v17, s40, v6
    v_dot2_f32_bf16 v6, v18, s40, v6
    v_dot2_f32_bf16 v6, v19, s40, v6
    v_dot2_f32_bf16 v7, v20, s40, v7
    v_dot2_f32_bf16 v7, v21, s40, v7
    v_dot2_f32_bf16 v7, v22, s40, v7
    v_dot2_f32_bf16 v7, v23, s40, v7
    v_dot2_f32_bf16 v8, v24, s40, v8
    v_dot2_f32_bf16 v8, v25, s40, v8
    v_dot2_f32_bf16 v8, v26, s40, v8
    v_dot2_f32_bf16 v8, v27, s40, v8
L_kqkv_kernel_nocs5:
    s_waitcnt vmcnt(4)
    s_barrier
    s_cmp_lg_u32 s57, 0
    s_cbranch_scc1 L_kqkv_kernel_nocs6
    ds_read_b64_tr_b16 v[16:17], v43 offset:16384
    ds_read_b64_tr_b16 v[18:19], v43 offset:17408
    ds_read_b64_tr_b16 v[20:21], v44 offset:16384
    ds_read_b64_tr_b16 v[22:23], v44 offset:17408
    ds_read_b64_tr_b16 v[24:25], v45 offset:16384
    ds_read_b64_tr_b16 v[26:27], v45 offset:17408
    s_waitcnt lgkmcnt(0)
    v_dot2_f32_bf16 v6, v16, s40, v6
    v_dot2_f32_bf16 v6, v17, s40, v6
    v_dot2_f32_bf16 v6, v18, s40, v6
    v_dot2_f32_bf16 v6, v19, s40, v6
    v_dot2_f32_bf16 v7, v20, s40, v7
    v_dot2_f32_bf16 v7, v21, s40, v7
    v_dot2_f32_bf16 v7, v22, s40, v7
    v_dot2_f32_bf16 v7, v23, s40, v7
    v_dot2_f32_bf16 v8, v24, s40, v8
    v_dot2_f32_bf16 v8, v25, s40, v8
    v_dot2_f32_bf16 v8, v26, s40, v8
    v_dot2_f32_bf16 v8, v27, s40, v8
L_kqkv_kernel_nocs6:
    s_waitcnt vmcnt(0)
    s_barrier
    s_cmp_lg_u32 s57, 1
    s_cbranch_scc1 L_kqkv_kernel_nocs7
    ds_read_b64_tr_b16 v[16:17], v43 offset:49152
    ds_read_b64_tr_b16 v[18:19], v43 offset:50176
    ds_read_b64_tr_b16 v[20:21], v44 offset:49152
    ds_read_b64_tr_b16 v[22:23], v44 offset:50176
    ds_read_b64_tr_b16 v[24:25], v45 offset:49152
    ds_read_b64_tr_b16 v[26:27], v45 offset:50176
    s_waitcnt lgkmcnt(0)
    v_dot2_f32_bf16 v6, v16, s40, v6
    v_dot2_f32_bf16 v6, v17, s40, v6
    v_dot2_f32_bf16 v6, v18, s40, v6
    v_dot2_f32_bf16 v6, v19, s40, v6
    v_dot2_f32_bf16 v7, v20, s40, v7
    v_dot2_f32_bf16 v7, v21, s40, v7
    v_dot2_f32_bf16 v7, v22, s40, v7
    v_dot2_f32_bf16 v7, v23, s40, v7
    v_dot2_f32_bf16 v8, v24, s40, v8
    v_dot2_f32_bf16 v8, v25, s40, v8
    v_dot2_f32_bf16 v8, v26, s40, v8
    v_dot2_f32_bf16 v8, v27, s40, v8
L_kqkv_kernel_nocs7:
    s_nop 2
    v_mov_b32 v9, v6
    s_nop 1
    v_permlane32_swap_b32 v6, v9
    s_nop 1
    v_add_f32 v6, v6, v9
    v_mov_b32 v9, v7
    s_nop 1
    v_permlane32_swap_b32 v7, v9
    s_nop 1
    v_add_f32 v7, v7, v9
    v_mov_b32 v9, v8
    s_nop 1
    v_permlane32_swap_b32 v8, v9
    s_nop 1
    v_add_f32 v8, v8, v9
    v_and_b32 v9, 31, v1
    v_lshlrev_b32 v9, 2, v9
    s_mul_i32 s36, s26, 384
    s_add_u32 s36, s36, 133120
    v_add_u32 v10, s36, v9
    ds_write_b32 v10, v6 offset:0
    ds_write_b32 v10, v7 offset:128
    ds_write_b32 v10, v8 offset:256
    s_waitcnt lgkmcnt(0)
    s_barrier
    s_branch L_kqkv_kernel_end
L_kqkv_kernel_compute:
    s_add_u32 s50, s50, s48
    s_mov_b32 s49, 0
    s_mov_b32 s42, s48
    s_lshl_b32 s27, s50, 5
    v_and_b32 v9, 31, v1
    v_add_u32 v14, s27, v9
    v_lshrrev_b32 v10, 1, v9
    v_and_b32 v10, 7, v10
    v_lshlrev_b32 v11, 7, v9
    s_lshl_b32 s36, s42, 12
    v_add_u32 v11, s36, v11
    v_xor_b32 v12, 0, v10
    v_xor_b32 v12, v12, v13
    v_lshlrev_b32 v12, 4, v12
    v_add_u32 v112, v11, v12
    v_xor_b32 v12, 2, v10
    v_xor_b32 v12, v12, v13
    v_lshlrev_b32 v12, 4, v12
    v_add_u32 v113, v11, v12
    v_xor_b32 v12, 4, v10
    v_xor_b32 v12, v12, v13
    v_lshlrev_b32 v12, 4, v12
    v_add_u32 v114, v11, v12
    v_xor_b32 v12, 6, v10
    v_xor_b32 v12, v12, v13
    v_lshlrev_b32 v12, 4, v12
    v_add_u32 v115, v11, v12
    v_mov_b32 v148, v112
    v_add_u32 v144, 65536, v112
    v_mov_b32 v149, v113
    v_add_u32 v145, 65536, v113
    v_mov_b32 v150, v114
    v_add_u32 v146, 65536, v114
    v_mov_b32 v151, v115
    v_add_u32 v147, 65536, v115
    v_lshrrev_b32 v9, 2, v1
    v_and_b32 v9, 3, v9
    v_lshlrev_b32 v10, 3, v13
    v_add_u32 v10, v10, v9
    v_lshlrev_b32 v10, 8, v10
    v_lshrrev_b32 v11, 4, v1
    v_and_b32 v11, 1, v11
    v_lshlrev_b32 v11, 5, v11
    v_and_b32 v12, 3, v1
    v_lshlrev_b32 v12, 3, v12
    v_add_u32 v10, v10, v11
    v_add_u32 v10, v10, v12
    v_xor_b32 v11, 0, v9
    v_lshlrev_b32 v11, 6, v11
    v_add_u32 v40, v10, v11
    v_add_u32 v43, 65536, v40
    v_xor_b32 v11, 1, v9
    v_lshlrev_b32 v11, 6, v11
    v_add_u32 v41, v10, v11
    v_add_u32 v44, 65536, v41
    v_xor_b32 v11, 2, v9
    v_lshlrev_b32 v11, 6, v11
    v_add_u32 v42, v10, v11
    v_add_u32 v45, 65536, v42
    v_add_u32 v61, 65536, v60
    s_mov_b32 s40, 0x3f803f80
    v_mov_b32 v4, 0
    v_mov_b32 v5, 0
    s_waitcnt lgkmcnt(0)
    s_mov_b32 s20, s10
    s_and_b32 s21, s11, 0xffff
    s_mov_b32 s22, 33554432
    s_mov_b32 s23, 0x00020000
    s_barrier
    s_barrier
    s_barrier
    ds_read_b128 v[52:55], v148 offset:0
    ds_read_b64_tr_b16 v[16:17], v40 offset:16384
    ds_read_b64_tr_b16 v[18:19], v40 offset:17408
    ds_read_b64_tr_b16 v[20:21], v41 offset:16384
    ds_read_b64_tr_b16 v[22:23], v41 offset:17408
    ds_read_b64_tr_b16 v[24:25], v42 offset:16384
    ds_read_b64_tr_b16 v[26:27], v42 offset:17408
    ds_read_b128 v[56:59], v149 offset:0
    ds_read_b64_tr_b16 v[28:29], v40 offset:20480
    ds_read_b64_tr_b16 v[30:31], v40 offset:21504
    ds_read_b64_tr_b16 v[32:33], v41 offset:20480
    ds_read_b64_tr_b16 v[34:35], v41 offset:21504
    ds_read_b64_tr_b16 v[36:37], v42 offset:20480
    ds_read_b64_tr_b16 v[38:39], v42 offset:21504
    s_waitcnt lgkmcnt(7)
    v_mfma_f32_32x32x16_bf16 v[64:79], v[16:19], v[52:55], 0
    v_dot2_f32_bf16 v4, v52, s40, v4
    v_dot2_f32_bf16 v4, v53, s40, v4
    v_dot2_f32_bf16 v4, v54, s40, v4
    v_dot2_f32_bf16 v4, v55, s40, v4
    v_mfma_f32_32x32x16_bf16 v[80:95], v[20:23], v[52:55], 0
    v_dot2_f32_bf16 v5, v52, v52, v5
    v_dot2_f32_bf16 v5, v53, v53, v5
    v_dot2_f32_bf16 v5, v54, v54, v5
    v_dot2_f32_bf16 v5, v55, v55, v5
    v_mfma_f32_32x32x16_bf16 v[96:111], v[52:55], v[24:27], 0
    ds_read_b128 v[52:55], v150 offset:0
    ds_read_b64_tr_b16 v[16:17], v40 offset:24576
    ds_read_b64_tr_b16 v[18:19], v40 offset:25600
    ds_read_b64_tr_b16 v[20:21], v41 offset:24576
    ds_read_b64_tr_b16 v[22:23], v41 offset:25600
    ds_read_b64_tr_b16 v[24:25], v42 offset:24576
    ds_read_b64_tr_b16 v[26:27], v42 offset:25600
    s_waitcnt lgkmcnt(7)
    v_mfma_f32_32x32x16_bf16 v[64:79], v[28:31], v[56:59], v[64:79]
    v_dot2_f32_bf16 v4, v56, s40, v4
    v_dot2_f32_bf16 v4, v57, s40, v4
    v_dot2_f32_bf16 v4, v58, s40, v4
    v_dot2_f32_bf16 v4, v59, s40, v4
    v_mfma_f32_32x32x16_bf16 v[80:95], v[32:35], v[56:59], v[80:95]
    v_dot2_f32_bf16 v5, v56, v56, v5
    v_dot2_f32_bf16 v5, v57, v57, v5
    v_dot2_f32_bf16 v5, v58, v58, v5
    v_dot2_f32_bf16 v5, v59, v59, v5
    v_mfma_f32_32x32x16_bf16 v[96:111], v[56:59], v[36:39], v[96:111]
    ds_read_b128 v[56:59], v151 offset:0
    ds_read_b64_tr_b16 v[28:29], v40 offset:28672
    ds_read_b64_tr_b16 v[30:31], v40 offset:29696
    ds_read_b64_tr_b16 v[32:33], v41 offset:28672
    ds_read_b64_tr_b16 v[34:35], v41 offset:29696
    ds_read_b64_tr_b16 v[36:37], v42 offset:28672
    ds_read_b64_tr_b16 v[38:39], v42 offset:29696
    s_waitcnt lgkmcnt(7)
    v_mfma_f32_32x32x16_bf16 v[64:79], v[16:19], v[52:55], v[64:79]
    v_dot2_f32_bf16 v4, v52, s40, v4
    v_dot2_f32_bf16 v4, v53, s40, v4
    v_dot2_f32_bf16 v4, v54, s40, v4
    v_dot2_f32_bf16 v4, v55, s40, v4
    v_mfma_f32_32x32x16_bf16 v[80:95], v[20:23], v[52:55], v[80:95]
    v_dot2_f32_bf16 v5, v52, v52, v5
    v_dot2_f32_bf16 v5, v53, v53, v5
    v_dot2_f32_bf16 v5, v54, v54, v5
    v_dot2_f32_bf16 v5, v55, v55, v5
    v_mfma_f32_32x32x16_bf16 v[96:111], v[52:55], v[24:27], v[96:111]
    s_waitcnt lgkmcnt(0)
    v_mfma_f32_32x32x16_bf16 v[64:79], v[28:31], v[56:59], v[64:79]
    v_dot2_f32_bf16 v4, v56, s40, v4
    v_dot2_f32_bf16 v4, v57, s40, v4
    v_dot2_f32_bf16 v4, v58, s40, v4
    v_dot2_f32_bf16 v4, v59, s40, v4
    v_mfma_f32_32x32x16_bf16 v[80:95], v[32:35], v[56:59], v[80:95]
    v_dot2_f32_bf16 v5, v56, v56, v5
    v_dot2_f32_bf16 v5, v57, v57, v5
    v_dot2_f32_bf16 v5, v58, v58, v5
    v_dot2_f32_bf16 v5, v59, v59, v5
    v_mfma_f32_32x32x16_bf16 v[96:111], v[56:59], v[36:39], v[96:111]
    s_barrier
    ds_read_b128 v[52:55], v148 offset:32768
    ds_read_b64_tr_b16 v[16:17], v40 offset:49152
    ds_read_b64_tr_b16 v[18:19], v40 offset:50176
    ds_read_b64_tr_b16 v[20:21], v41 offset:49152
    ds_read_b64_tr_b16 v[22:23], v41 offset:50176
    ds_read_b64_tr_b16 v[24:25], v42 offset:49152
    ds_read_b64_tr_b16 v[26:27], v42 offset:50176
    ds_read_b128 v[56:59], v149 offset:32768
    ds_read_b64_tr_b16 v[28:29], v40 offset:53248
    ds_read_b64_tr_b16 v[30:31], v40 offset:54272
    ds_read_b64_tr_b16 v[32:33], v41 offset:53248
    ds_read_b64_tr_b16 v[34:35], v41 offset:54272
    ds_read_b64_tr_b16 v[36:37], v42 offset:53248
    ds_read_b64_tr_b16 v[38:39], v42 offset:54272
    s_waitcnt lgkmcnt(7)
    v_mfma_f32_32x32x16_bf16 v[64:79], v[16:19], v[52:55], v[64:79]
    v_dot2_f32_bf16 v4, v52, s40, v4
    v_dot2_f32_bf16 v4, v53, s40, v4
    v_dot2_f32_bf16 v4, v54, s40, v4
    v_dot2_f32_bf16 v4, v55, s40, v4
    v_mfma_f32_32x32x16_bf16 v[80:95], v[20:23], v[52:55], v[80:95]
    v_dot2_f32_bf16 v5, v52, v52, v5
    v_dot2_f32_bf16 v5, v53, v53, v5
    v_dot2_f32_bf16 v5, v54, v54, v5
    v_dot2_f32_bf16 v5, v55, v55, v5
    v_mfma_f32_32x32x16_bf16 v[96:111], v[52:55], v[24:27], v[96:111]
    ds_read_b128 v[52:55], v150 offset:32768
    ds_read_b64_tr_b16 v[16:17], v40 offset:57344
    ds_read_b64_tr_b16 v[18:19], v40 offset:58368
    ds_read_b64_tr_b16 v[20:21], v41 offset:57344
    ds_read_b64_tr_b16 v[22:23], v41 offset:58368
    ds_read_b64_tr_b16 v[24:25], v42 offset:57344
    ds_read_b64_tr_b16 v[26:27], v42 offset:58368
    s_waitcnt lgkmcnt(7)
    v_mfma_f32_32x32x16_bf16 v[64:79], v[28:31], v[56:59], v[64:79]
    v_dot2_f32_bf16 v4, v56, s40, v4
    v_dot2_f32_bf16 v4, v57, s40, v4
    v_dot2_f32_bf16 v4, v58, s40, v4
    v_dot2_f32_bf16 v4, v59, s40, v4
    v_mfma_f32_32x32x16_bf16 v[80:95], v[32:35], v[56:59], v[80:95]
    v_dot2_f32_bf16 v5, v56, v56, v5
    v_dot2_f32_bf16 v5, v57, v57, v5
    v_dot2_f32_bf16 v5, v58, v58, v5
    v_dot2_f32_bf16 v5, v59, v59, v5
    v_mfma_f32_32x32x16_bf16 v[96:111], v[56:59], v[36:39], v[96:111]
    ds_read_b128 v[56:59], v151 offset:32768
    ds_read_b64_tr_b16 v[28:29], v40 offset:61440
    ds_read_b64_tr_b16 v[30:31], v40 offset:62464
    ds_read_b64_tr_b16 v[32:33], v41 offset:61440
    ds_read_b64_tr_b16 v[34:35], v41 offset:62464
    ds_read_b64_tr_b16 v[36:37], v42 offset:61440
    ds_read_b64_tr_b16 v[38:39], v42 offset:62464
    s_waitcnt lgkmcnt(7)
    v_mfma_f32_32x32x16_bf16 v[64:79], v[16:19], v[52:55], v[64:79]
    v_dot2_f32_bf16 v4, v52, s40, v4
    v_dot2_f32_bf16 v4, v53, s40, v4
    v_dot2_f32_bf16 v4, v54, s40, v4
    v_dot2_f32_bf16 v4, v55, s40, v4
    v_mfma_f32_32x32x16_bf16 v[80:95], v[20:23], v[52:55], v[80:95]
    v_dot2_f32_bf16 v5, v52, v52, v5
    v_dot2_f32_bf16 v5, v53, v53, v5
    v_dot2_f32_bf16 v5, v54, v54, v5
    v_dot2_f32_bf16 v5, v55, v55, v5
    v_mfma_f32_32x32x16_bf16 v[96:111], v[52:55], v[24:27], v[96:111]
    s_waitcnt lgkmcnt(0)
    v_mfma_f32_32x32x16_bf16 v[64:79], v[28:31], v[56:59], v[64:79]
    v_dot2_f32_bf16 v4, v56, s40, v4
    v_dot2_f32_bf16 v4, v57, s40, v4
    v_dot2_f32_bf16 v4, v58, s40, v4
    v_dot2_f32_bf16 v4, v59, s40, v4
    v_mfma_f32_32x32x16_bf16 v[80:95], v[32:35], v[56:59], v[80:95]
    v_dot2_f32_bf16 v5, v56, v56, v5
    v_dot2_f32_bf16 v5, v57, v57, v5
    v_dot2_f32_bf16 v5, v58, v58, v5
    v_dot2_f32_bf16 v5, v59, v59, v5
    v_mfma_f32_32x32x16_bf16 v[96:111], v[56:59], v[36:39], v[96:111]
    s_barrier
    ds_read_b128 v[52:55], v144 offset:0
    ds_read_b64_tr_b16 v[16:17], v43 offset:16384
    ds_read_b64_tr_b16 v[18:19], v43 offset:17408
    ds_read_b64_tr_b16 v[20:21], v44 offset:16384
    ds_read_b64_tr_b16 v[22:23], v44 offset:17408
    ds_read_b64_tr_b16 v[24:25], v45 offset:16384
    ds_read_b64_tr_b16 v[26:27], v45 offset:17408
    ds_read_b128 v[56:59], v145 offset:0
    ds_read_b64_tr_b16 v[28:29], v43 offset:20480
    ds_read_b64_tr_b16 v[30:31], v43 offset:21504
    ds_read_b64_tr_b16 v[32:33], v44 offset:20480
    ds_read_b64_tr_b16 v[34:35], v44 offset:21504
    ds_read_b64_tr_b16 v[36:37], v45 offset:20480
    ds_read_b64_tr_b16 v[38:39], v45 offset:21504
    s_waitcnt lgkmcnt(7)
    v_mfma_f32_32x32x16_bf16 v[64:79], v[16:19], v[52:55], v[64:79]
    v_dot2_f32_bf16 v4, v52, s40, v4
    v_dot2_f32_bf16 v4, v53, s40, v4
    v_dot2_f32_bf16 v4, v54, s40, v4
    v_dot2_f32_bf16 v4, v55, s40, v4
    v_mfma_f32_32x32x16_bf16 v[80:95], v[20:23], v[52:55], v[80:95]
    v_dot2_f32_bf16 v5, v52, v52, v5
    v_dot2_f32_bf16 v5, v53, v53, v5
    v_dot2_f32_bf16 v5, v54, v54, v5
    v_dot2_f32_bf16 v5, v55, v55, v5
    v_mfma_f32_32x32x16_bf16 v[96:111], v[52:55], v[24:27], v[96:111]
    ds_read_b128 v[52:55], v146 offset:0
    ds_read_b64_tr_b16 v[16:17], v43 offset:24576
    ds_read_b64_tr_b16 v[18:19], v43 offset:25600
    ds_read_b64_tr_b16 v[20:21], v44 offset:24576
    ds_read_b64_tr_b16 v[22:23], v44 offset:25600
    ds_read_b64_tr_b16 v[24:25], v45 offset:24576
    ds_read_b64_tr_b16 v[26:27], v45 offset:25600
    s_waitcnt lgkmcnt(7)
    v_mfma_f32_32x32x16_bf16 v[64:79], v[28:31], v[56:59], v[64:79]
    v_dot2_f32_bf16 v4, v56, s40, v4
    v_dot2_f32_bf16 v4, v57, s40, v4
    v_dot2_f32_bf16 v4, v58, s40, v4
    v_dot2_f32_bf16 v4, v59, s40, v4
    v_mfma_f32_32x32x16_bf16 v[80:95], v[32:35], v[56:59], v[80:95]
    v_dot2_f32_bf16 v5, v56, v56, v5
    v_dot2_f32_bf16 v5, v57, v57, v5
    v_dot2_f32_bf16 v5, v58, v58, v5
    v_dot2_f32_bf16 v5, v59, v59, v5
    v_mfma_f32_32x32x16_bf16 v[96:111], v[56:59], v[36:39], v[96:111]
    ds_read_b128 v[56:59], v147 offset:0
    ds_read_b64_tr_b16 v[28:29], v43 offset:28672
    ds_read_b64_tr_b16 v[30:31], v43 offset:29696
    ds_read_b64_tr_b16 v[32:33], v44 offset:28672
    ds_read_b64_tr_b16 v[34:35], v44 offset:29696
    ds_read_b64_tr_b16 v[36:37], v45 offset:28672
    ds_read_b64_tr_b16 v[38:39], v45 offset:29696
    s_waitcnt lgkmcnt(7)
    v_mfma_f32_32x32x16_bf16 v[64:79], v[16:19], v[52:55], v[64:79]
    v_dot2_f32_bf16 v4, v52, s40, v4
    v_dot2_f32_bf16 v4, v53, s40, v4
    v_dot2_f32_bf16 v4, v54, s40, v4
    v_dot2_f32_bf16 v4, v55, s40, v4
    v_mfma_f32_32x32x16_bf16 v[80:95], v[20:23], v[52:55], v[80:95]
    v_dot2_f32_bf16 v5, v52, v52, v5
    v_dot2_f32_bf16 v5, v53, v53, v5
    v_dot2_f32_bf16 v5, v54, v54, v5
    v_dot2_f32_bf16 v5, v55, v55, v5
    v_mfma_f32_32x32x16_bf16 v[96:111], v[52:55], v[24:27], v[96:111]
    s_waitcnt lgkmcnt(0)
    v_mfma_f32_32x32x16_bf16 v[64:79], v[28:31], v[56:59], v[64:79]
    v_dot2_f32_bf16 v4, v56, s40, v4
    v_dot2_f32_bf16 v4, v57, s40, v4
    v_dot2_f32_bf16 v4, v58, s40, v4
    v_dot2_f32_bf16 v4, v59, s40, v4
    v_mfma_f32_32x32x16_bf16 v[80:95], v[32:35], v[56:59], v[80:95]
    v_dot2_f32_bf16 v5, v56, v56, v5
    v_dot2_f32_bf16 v5, v57, v57, v5
    v_dot2_f32_bf16 v5, v58, v58, v5
    v_dot2_f32_bf16 v5, v59, v59, v5
    v_mfma_f32_32x32x16_bf16 v[96:111], v[56:59], v[36:39], v[96:111]
    s_barrier
    ds_read_b128 v[52:55], v144 offset:32768
    ds_read_b64_tr_b16 v[16:17], v43 offset:49152
    ds_read_b64_tr_b16 v[18:19], v43 offset:50176
    ds_read_b64_tr_b16 v[20:21], v44 offset:49152
    ds_read_b64_tr_b16 v[22:23], v44 offset:50176
    ds_read_b64_tr_b16 v[24:25], v45 offset:49152
    ds_read_b64_tr_b16 v[26:27], v45 offset:50176
    ds_read_b128 v[56:59], v145 offset:32768
    ds_read_b64_tr_b16 v[28:29], v43 offset:53248
    ds_read_b64_tr_b16 v[30:31], v43 offset:54272
    ds_read_b64_tr_b16 v[32:33], v44 offset:53248
    ds_read_b64_tr_b16 v[34:35], v44 offset:54272
    ds_read_b64_tr_b16 v[36:37], v45 offset:53248
    ds_read_b64_tr_b16 v[38:39], v45 offset:54272
    s_waitcnt lgkmcnt(7)
    v_mfma_f32_32x32x16_bf16 v[64:79], v[16:19], v[52:55], v[64:79]
    v_dot2_f32_bf16 v4, v52, s40, v4
    v_dot2_f32_bf16 v4, v53, s40, v4
    v_dot2_f32_bf16 v4, v54, s40, v4
    v_dot2_f32_bf16 v4, v55, s40, v4
    v_mfma_f32_32x32x16_bf16 v[80:95], v[20:23], v[52:55], v[80:95]
    v_dot2_f32_bf16 v5, v52, v52, v5
    v_dot2_f32_bf16 v5, v53, v53, v5
    v_dot2_f32_bf16 v5, v54, v54, v5
    v_dot2_f32_bf16 v5, v55, v55, v5
    v_mfma_f32_32x32x16_bf16 v[96:111], v[52:55], v[24:27], v[96:111]
    ds_read_b128 v[52:55], v146 offset:32768
    ds_read_b64_tr_b16 v[16:17], v43 offset:57344
    ds_read_b64_tr_b16 v[18:19], v43 offset:58368
    ds_read_b64_tr_b16 v[20:21], v44 offset:57344
    ds_read_b64_tr_b16 v[22:23], v44 offset:58368
    ds_read_b64_tr_b16 v[24:25], v45 offset:57344
    ds_read_b64_tr_b16 v[26:27], v45 offset:58368
    s_waitcnt lgkmcnt(7)
    v_mfma_f32_32x32x16_bf16 v[64:79], v[28:31], v[56:59], v[64:79]
    v_dot2_f32_bf16 v4, v56, s40, v4
    v_dot2_f32_bf16 v4, v57, s40, v4
    v_dot2_f32_bf16 v4, v58, s40, v4
    v_dot2_f32_bf16 v4, v59, s40, v4
    v_mfma_f32_32x32x16_bf16 v[80:95], v[32:35], v[56:59], v[80:95]
    v_dot2_f32_bf16 v5, v56, v56, v5
    v_dot2_f32_bf16 v5, v57, v57, v5
    v_dot2_f32_bf16 v5, v58, v58, v5
    v_dot2_f32_bf16 v5, v59, v59, v5
    v_mfma_f32_32x32x16_bf16 v[96:111], v[56:59], v[36:39], v[96:111]
    ds_read_b128 v[56:59], v147 offset:32768
    ds_read_b64_tr_b16 v[28:29], v43 offset:61440
    ds_read_b64_tr_b16 v[30:31], v43 offset:62464
    ds_read_b64_tr_b16 v[32:33], v44 offset:61440
    ds_read_b64_tr_b16 v[34:35], v44 offset:62464
    ds_read_b64_tr_b16 v[36:37], v45 offset:61440
    ds_read_b64_tr_b16 v[38:39], v45 offset:62464
    s_waitcnt lgkmcnt(7)
    v_mfma_f32_32x32x16_bf16 v[64:79], v[16:19], v[52:55], v[64:79]
    v_dot2_f32_bf16 v4, v52, s40, v4
    v_dot2_f32_bf16 v4, v53, s40, v4
    v_dot2_f32_bf16 v4, v54, s40, v4
    v_dot2_f32_bf16 v4, v55, s40, v4
    v_mfma_f32_32x32x16_bf16 v[80:95], v[20:23], v[52:55], v[80:95]
    v_dot2_f32_bf16 v5, v52, v52, v5
    v_dot2_f32_bf16 v5, v53, v53, v5
    v_dot2_f32_bf16 v5, v54, v54, v5
    v_dot2_f32_bf16 v5, v55, v55, v5
    v_mfma_f32_32x32x16_bf16 v[96:111], v[52:55], v[24:27], v[96:111]
    s_waitcnt lgkmcnt(0)
    v_mfma_f32_32x32x16_bf16 v[64:79], v[28:31], v[56:59], v[64:79]
    v_dot2_f32_bf16 v4, v56, s40, v4
    v_dot2_f32_bf16 v4, v57, s40, v4
    v_dot2_f32_bf16 v4, v58, s40, v4
    v_dot2_f32_bf16 v4, v59, s40, v4
    v_mfma_f32_32x32x16_bf16 v[80:95], v[32:35], v[56:59], v[80:95]
    v_dot2_f32_bf16 v5, v56, v56, v5
    v_dot2_f32_bf16 v5, v57, v57, v5
    v_dot2_f32_bf16 v5, v58, v58, v5
    v_dot2_f32_bf16 v5, v59, v59, v5
    v_mfma_f32_32x32x16_bf16 v[96:111], v[56:59], v[36:39], v[96:111]
    s_barrier
    ds_read_b128 v[52:55], v148 offset:0
    ds_read_b64_tr_b16 v[16:17], v40 offset:16384
    ds_read_b64_tr_b16 v[18:19], v40 offset:17408
    ds_read_b64_tr_b16 v[20:21], v41 offset:16384
    ds_read_b64_tr_b16 v[22:23], v41 offset:17408
    ds_read_b64_tr_b16 v[24:25], v42 offset:16384
    ds_read_b64_tr_b16 v[26:27], v42 offset:17408
    ds_read_b128 v[56:59], v149 offset:0
    ds_read_b64_tr_b16 v[28:29], v40 offset:20480
    ds_read_b64_tr_b16 v[30:31], v40 offset:21504
    ds_read_b64_tr_b16 v[32:33], v41 offset:20480
    ds_read_b64_tr_b16 v[34:35], v41 offset:21504
    ds_read_b64_tr_b16 v[36:37], v42 offset:20480
    ds_read_b64_tr_b16 v[38:39], v42 offset:21504
    s_waitcnt lgkmcnt(7)
    v_mfma_f32_32x32x16_bf16 v[64:79], v[16:19], v[52:55], v[64:79]
    v_dot2_f32_bf16 v4, v52, s40, v4
    v_dot2_f32_bf16 v4, v53, s40, v4
    v_dot2_f32_bf16 v4, v54, s40, v4
    v_dot2_f32_bf16 v4, v55, s40, v4
    v_mfma_f32_32x32x16_bf16 v[80:95], v[20:23], v[52:55], v[80:95]
    v_dot2_f32_bf16 v5, v52, v52, v5
    v_dot2_f32_bf16 v5, v53, v53, v5
    v_dot2_f32_bf16 v5, v54, v54, v5
    v_dot2_f32_bf16 v5, v55, v55, v5
    v_mfma_f32_32x32x16_bf16 v[96:111], v[52:55], v[24:27], v[96:111]
    ds_read_b128 v[52:55], v150 offset:0
    ds_read_b64_tr_b16 v[16:17], v40 offset:24576
    ds_read_b64_tr_b16 v[18:19], v40 offset:25600
    ds_read_b64_tr_b16 v[20:21], v41 offset:24576
    ds_read_b64_tr_b16 v[22:23], v41 offset:25600
    ds_read_b64_tr_b16 v[24:25], v42 offset:24576
    ds_read_b64_tr_b16 v[26:27], v42 offset:25600
    s_waitcnt lgkmcnt(7)
    v_mfma_f32_32x32x16_bf16 v[64:79], v[28:31], v[56:59], v[64:79]
    v_dot2_f32_bf16 v4, v56, s40, v4
    v_dot2_f32_bf16 v4, v57, s40, v4
    v_dot2_f32_bf16 v4, v58, s40, v4
    v_dot2_f32_bf16 v4, v59, s40, v4
    v_mfma_f32_32x32x16_bf16 v[80:95], v[32:35], v[56:59], v[80:95]
    v_dot2_f32_bf16 v5, v56, v56, v5
    v_dot2_f32_bf16 v5, v57, v57, v5
    v_dot2_f32_bf16 v5, v58, v58, v5
    v_dot2_f32_bf16 v5, v59, v59, v5
    v_mfma_f32_32x32x16_bf16 v[96:111], v[56:59], v[36:39], v[96:111]
    ds_read_b128 v[56:59], v151 offset:0
    ds_read_b64_tr_b16 v[28:29], v40 offset:28672
    ds_read_b64_tr_b16 v[30:31], v40 offset:29696
    ds_read_b64_tr_b16 v[32:33], v41 offset:28672
    ds_read_b64_tr_b16 v[34:35], v41 offset:29696
    ds_read_b64_tr_b16 v[36:37], v42 offset:28672
    ds_read_b64_tr_b16 v[38:39], v42 offset:29696
    s_waitcnt lgkmcnt(7)
    v_mfma_f32_32x32x16_bf16 v[64:79], v[16:19], v[52:55], v[64:79]
    v_dot2_f32_bf16 v4, v52, s40, v4
    v_dot2_f32_bf16 v4, v53, s40, v4
    v_dot2_f32_bf16 v4, v54, s40, v4
    v_dot2_f32_bf16 v4, v55, s40, v4
    v_mfma_f32_32x32x16_bf16 v[80:95], v[20:23], v[52:55], v[80:95]
    v_dot2_f32_bf16 v5, v52, v52, v5
    v_dot2_f32_bf16 v5, v53, v53, v5
    v_dot2_f32_bf16 v5, v54, v54, v5
    v_dot2_f32_bf16 v5, v55, v55, v5
    v_mfma_f32_32x32x16_bf16 v[96:111], v[52:55], v[24:27], v[96:111]
    s_waitcnt lgkmcnt(0)
    v_mfma_f32_32x32x16_bf16 v[64:79], v[28:31], v[56:59], v[64:79]
    v_dot2_f32_bf16 v4, v56, s40, v4
    v_dot2_f32_bf16 v4, v57, s40, v4
    v_dot2_f32_bf16 v4, v58, s40, v4
    v_dot2_f32_bf16 v4, v59, s40, v4
    v_mfma_f32_32x32x16_bf16 v[80:95], v[32:35], v[56:59], v[80:95]
    v_dot2_f32_bf16 v5, v56, v56, v5
    v_dot2_f32_bf16 v5, v57, v57, v5
    v_dot2_f32_bf16 v5, v58, v58, v5
    v_dot2_f32_bf16 v5, v59, v59, v5
    v_mfma_f32_32x32x16_bf16 v[96:111], v[56:59], v[36:39], v[96:111]
    s_barrier
    ds_read_b128 v[52:55], v148 offset:32768
    ds_read_b64_tr_b16 v[16:17], v40 offset:49152
    ds_read_b64_tr_b16 v[18:19], v40 offset:50176
    ds_read_b64_tr_b16 v[20:21], v41 offset:49152
    ds_read_b64_tr_b16 v[22:23], v41 offset:50176
    ds_read_b64_tr_b16 v[24:25], v42 offset:49152
    ds_read_b64_tr_b16 v[26:27], v42 offset:50176
    ds_read_b128 v[56:59], v149 offset:32768
    ds_read_b64_tr_b16 v[28:29], v40 offset:53248
    ds_read_b64_tr_b16 v[30:31], v40 offset:54272
    ds_read_b64_tr_b16 v[32:33], v41 offset:53248
    ds_read_b64_tr_b16 v[34:35], v41 offset:54272
    ds_read_b64_tr_b16 v[36:37], v42 offset:53248
    ds_read_b64_tr_b16 v[38:39], v42 offset:54272
    s_waitcnt lgkmcnt(7)
    v_mfma_f32_32x32x16_bf16 v[64:79], v[16:19], v[52:55], v[64:79]
    v_dot2_f32_bf16 v4, v52, s40, v4
    v_dot2_f32_bf16 v4, v53, s40, v4
    v_dot2_f32_bf16 v4, v54, s40, v4
    v_dot2_f32_bf16 v4, v55, s40, v4
    v_mfma_f32_32x32x16_bf16 v[80:95], v[20:23], v[52:55], v[80:95]
    v_dot2_f32_bf16 v5, v52, v52, v5
    v_dot2_f32_bf16 v5, v53, v53, v5
    v_dot2_f32_bf16 v5, v54, v54, v5
    v_dot2_f32_bf16 v5, v55, v55, v5
    v_mfma_f32_32x32x16_bf16 v[96:111], v[52:55], v[24:27], v[96:111]
    ds_read_b128 v[52:55], v150 offset:32768
    ds_read_b64_tr_b16 v[16:17], v40 offset:57344
    ds_read_b64_tr_b16 v[18:19], v40 offset:58368
    ds_read_b64_tr_b16 v[20:21], v41 offset:57344
    ds_read_b64_tr_b16 v[22:23], v41 offset:58368
    ds_read_b64_tr_b16 v[24:25], v42 offset:57344
    ds_read_b64_tr_b16 v[26:27], v42 offset:58368
    s_waitcnt lgkmcnt(7)
    v_mfma_f32_32x32x16_bf16 v[64:79], v[28:31], v[56:59], v[64:79]
    v_dot2_f32_bf16 v4, v56, s40, v4
    v_dot2_f32_bf16 v4, v57, s40, v4
    v_dot2_f32_bf16 v4, v58, s40, v4
    v_dot2_f32_bf16 v4, v59, s40, v4
    v_mfma_f32_32x32x16_bf16 v[80:95], v[32:35], v[56:59], v[80:95]
    v_dot2_f32_bf16 v5, v56, v56, v5
    v_dot2_f32_bf16 v5, v57, v57, v5
    v_dot2_f32_bf16 v5, v58, v58, v5
    v_dot2_f32_bf16 v5, v59, v59, v5
    v_mfma_f32_32x32x16_bf16 v[96:111], v[56:59], v[36:39], v[96:111]
    ds_read_b128 v[56:59], v151 offset:32768
    ds_read_b64_tr_b16 v[28:29], v40 offset:61440
    ds_read_b64_tr_b16 v[30:31], v40 offset:62464
    ds_read_b64_tr_b16 v[32:33], v41 offset:61440
    ds_read_b64_tr_b16 v[34:35], v41 offset:62464
    ds_read_b64_tr_b16 v[36:37], v42 offset:61440
    ds_read_b64_tr_b16 v[38:39], v42 offset:62464
    s_waitcnt lgkmcnt(7)
    v_mfma_f32_32x32x16_bf16 v[64:79], v[16:19], v[52:55], v[64:79]
    v_dot2_f32_bf16 v4, v52, s40, v4
    v_dot2_f32_bf16 v4, v53, s40, v4
    v_dot2_f32_bf16 v4, v54, s40, v4
    v_dot2_f32_bf16 v4, v55, s40, v4
    v_mfma_f32_32x32x16_bf16 v[80:95], v[20:23], v[52:55], v[80:95]
    v_dot2_f32_bf16 v5, v52, v52, v5
    v_dot2_f32_bf16 v5, v53, v53, v5
    v_dot2_f32_bf16 v5, v54, v54, v5
    v_dot2_f32_bf16 v5, v55, v55, v5
    v_mfma_f32_32x32x16_bf16 v[96:111], v[52:55], v[24:27], v[96:111]
    s_waitcnt lgkmcnt(0)
    v_mfma_f32_32x32x16_bf16 v[64:79], v[28:31], v[56:59], v[64:79]
    v_dot2_f32_bf16 v4, v56, s40, v4
    v_dot2_f32_bf16 v4, v57, s40, v4
    v_dot2_f32_bf16 v4, v58, s40, v4
    v_dot2_f32_bf16 v4, v59, s40, v4
    v_mfma_f32_32x32x16_bf16 v[80:95], v[32:35], v[56:59], v[80:95]
    v_dot2_f32_bf16 v5, v56, v56, v5
    v_dot2_f32_bf16 v5, v57, v57, v5
    v_dot2_f32_bf16 v5, v58, v58, v5
    v_dot2_f32_bf16 v5, v59, v59, v5
    v_mfma_f32_32x32x16_bf16 v[96:111], v[56:59], v[36:39], v[96:111]
    s_barrier
    ds_read_b128 v[52:55], v144 offset:0
    ds_read_b64_tr_b16 v[16:17], v43 offset:16384
    ds_read_b64_tr_b16 v[18:19], v43 offset:17408
    ds_read_b64_tr_b16 v[20:21], v44 offset:16384
    ds_read_b64_tr_b16 v[22:23], v44 offset:17408
    ds_read_b64_tr_b16 v[24:25], v45 offset:16384
    ds_read_b64_tr_b16 v[26:27], v45 offset:17408
    ds_read_b128 v[56:59], v145 offset:0
    ds_read_b64_tr_b16 v[28:29], v43 offset:20480
    ds_read_b64_tr_b16 v[30:31], v43 offset:21504
    ds_read_b64_tr_b16 v[32:33], v44 offset:20480
    ds_read_b64_tr_b16 v[34:35], v44 offset:21504
    ds_read_b64_tr_b16 v[36:37], v45 offset:20480
    ds_read_b64_tr_b16 v[38:39], v45 offset:21504
    s_waitcnt lgkmcnt(7)
    v_mfma_f32_32x32x16_bf16 v[64:79], v[16:19], v[52:55], v[64:79]
    v_dot2_f32_bf16 v4, v52, s40, v4
    v_dot2_f32_bf16 v4, v53, s40, v4
    v_dot2_f32_bf16 v4, v54, s40, v4
    v_dot2_f32_bf16 v4, v55, s40, v4
    v_mfma_f32_32x32x16_bf16 v[80:95], v[20:23], v[52:55], v[80:95]
    v_dot2_f32_bf16 v5, v52, v52, v5
    v_dot2_f32_bf16 v5, v53, v53, v5
    v_dot2_f32_bf16 v5, v54, v54, v5
    v_dot2_f32_bf16 v5, v55, v55, v5
    v_mfma_f32_32x32x16_bf16 v[96:111], v[52:55], v[24:27], v[96:111]
    ds_read_b128 v[52:55], v146 offset:0
    ds_read_b64_tr_b16 v[16:17], v43 offset:24576
    ds_read_b64_tr_b16 v[18:19], v43 offset:25600
    ds_read_b64_tr_b16 v[20:21], v44 offset:24576
    ds_read_b64_tr_b16 v[22:23], v44 offset:25600
    ds_read_b64_tr_b16 v[24:25], v45 offset:24576
    ds_read_b64_tr_b16 v[26:27], v45 offset:25600
    s_waitcnt lgkmcnt(7)
    v_mfma_f32_32x32x16_bf16 v[64:79], v[28:31], v[56:59], v[64:79]
    v_dot2_f32_bf16 v4, v56, s40, v4
    v_dot2_f32_bf16 v4, v57, s40, v4
    v_dot2_f32_bf16 v4, v58, s40, v4
    v_dot2_f32_bf16 v4, v59, s40, v4
    v_mfma_f32_32x32x16_bf16 v[80:95], v[32:35], v[56:59], v[80:95]
    v_dot2_f32_bf16 v5, v56, v56, v5
    v_dot2_f32_bf16 v5, v57, v57, v5
    v_dot2_f32_bf16 v5, v58, v58, v5
    v_dot2_f32_bf16 v5, v59, v59, v5
    v_mfma_f32_32x32x16_bf16 v[96:111], v[56:59], v[36:39], v[96:111]
    ds_read_b128 v[56:59], v147 offset:0
    ds_read_b64_tr_b16 v[28:29], v43 offset:28672
    ds_read_b64_tr_b16 v[30:31], v43 offset:29696
    ds_read_b64_tr_b16 v[32:33], v44 offset:28672
    ds_read_b64_tr_b16 v[34:35], v44 offset:29696
    ds_read_b64_tr_b16 v[36:37], v45 offset:28672
    ds_read_b64_tr_b16 v[38:39], v45 offset:29696
    s_waitcnt lgkmcnt(7)
    v_mfma_f32_32x32x16_bf16 v[64:79], v[16:19], v[52:55], v[64:79]
    v_dot2_f32_bf16 v4, v52, s40, v4
    v_dot2_f32_bf16 v4, v53, s40, v4
    v_dot2_f32_bf16 v4, v54, s40, v4
    v_dot2_f32_bf16 v4, v55, s40, v4
    v_mfma_f32_32x32x16_bf16 v[80:95], v[20:23], v[52:55], v[80:95]
    v_dot2_f32_bf16 v5, v52, v52, v5
    v_dot2_f32_bf16 v5, v53, v53, v5
    v_dot2_f32_bf16 v5, v54, v54, v5
    v_dot2_f32_bf16 v5, v55, v55, v5
    v_mfma_f32_32x32x16_bf16 v[96:111], v[52:55], v[24:27], v[96:111]
    s_waitcnt lgkmcnt(0)
    v_mfma_f32_32x32x16_bf16 v[64:79], v[28:31], v[56:59], v[64:79]
    v_dot2_f32_bf16 v4, v56, s40, v4
    v_dot2_f32_bf16 v4, v57, s40, v4
    v_dot2_f32_bf16 v4, v58, s40, v4
    v_dot2_f32_bf16 v4, v59, s40, v4
    v_mfma_f32_32x32x16_bf16 v[80:95], v[32:35], v[56:59], v[80:95]
    v_dot2_f32_bf16 v5, v56, v56, v5
    v_dot2_f32_bf16 v5, v57, v57, v5
    v_dot2_f32_bf16 v5, v58, v58, v5
    v_dot2_f32_bf16 v5, v59, v59, v5
    v_mfma_f32_32x32x16_bf16 v[96:111], v[56:59], v[36:39], v[96:111]
    s_barrier
    ds_read_b128 v[52:55], v144 offset:32768
    ds_read_b64_tr_b16 v[16:17], v43 offset:49152
    ds_read_b64_tr_b16 v[18:19], v43 offset:50176
    ds_read_b64_tr_b16 v[20:21], v44 offset:49152
    ds_read_b64_tr_b16 v[22:23], v44 offset:50176
    ds_read_b64_tr_b16 v[24:25], v45 offset:49152
    ds_read_b64_tr_b16 v[26:27], v45 offset:50176
    ds_read_b128 v[56:59], v145 offset:32768
    ds_read_b64_tr_b16 v[28:29], v43 offset:53248
    ds_read_b64_tr_b16 v[30:31], v43 offset:54272
    ds_read_b64_tr_b16 v[32:33], v44 offset:53248
    ds_read_b64_tr_b16 v[34:35], v44 offset:54272
    ds_read_b64_tr_b16 v[36:37], v45 offset:53248
    ds_read_b64_tr_b16 v[38:39], v45 offset:54272
    s_waitcnt lgkmcnt(7)
    v_mfma_f32_32x32x16_bf16 v[64:79], v[16:19], v[52:55], v[64:79]
    v_dot2_f32_bf16 v4, v52, s40, v4
    v_dot2_f32_bf16 v4, v53, s40, v4
    v_dot2_f32_bf16 v4, v54, s40, v4
    v_dot2_f32_bf16 v4, v55, s40, v4
    v_mfma_f32_32x32x16_bf16 v[80:95], v[20:23], v[52:55], v[80:95]
    v_dot2_f32_bf16 v5, v52, v52, v5
    v_dot2_f32_bf16 v5, v53, v53, v5
    v_dot2_f32_bf16 v5, v54, v54, v5
    v_dot2_f32_bf16 v5, v55, v55, v5
    v_mfma_f32_32x32x16_bf16 v[96:111], v[52:55], v[24:27], v[96:111]
    ds_read_b128 v[52:55], v146 offset:32768
    ds_read_b64_tr_b16 v[16:17], v43 offset:57344
    ds_read_b64_tr_b16 v[18:19], v43 offset:58368
    ds_read_b64_tr_b16 v[20:21], v44 offset:57344
    ds_read_b64_tr_b16 v[22:23], v44 offset:58368
    ds_read_b64_tr_b16 v[24:25], v45 offset:57344
    ds_read_b64_tr_b16 v[26:27], v45 offset:58368
    s_waitcnt lgkmcnt(7)
    v_mfma_f32_32x32x16_bf16 v[64:79], v[28:31], v[56:59], v[64:79]
    v_dot2_f32_bf16 v4, v56, s40, v4
    v_dot2_f32_bf16 v4, v57, s40, v4
    v_dot2_f32_bf16 v4, v58, s40, v4
    v_dot2_f32_bf16 v4, v59, s40, v4
    v_mfma_f32_32x32x16_bf16 v[80:95], v[32:35], v[56:59], v[80:95]
    v_dot2_f32_bf16 v5, v56, v56, v5
    v_dot2_f32_bf16 v5, v57, v57, v5
    v_dot2_f32_bf16 v5, v58, v58, v5
    v_dot2_f32_bf16 v5, v59, v59, v5
    v_mfma_f32_32x32x16_bf16 v[96:111], v[56:59], v[36:39], v[96:111]
    ds_read_b128 v[56:59], v147 offset:32768
    ds_read_b64_tr_b16 v[28:29], v43 offset:61440
    ds_read_b64_tr_b16 v[30:31], v43 offset:62464
    ds_read_b64_tr_b16 v[32:33], v44 offset:61440
    ds_read_b64_tr_b16 v[34:35], v44 offset:62464
    ds_read_b64_tr_b16 v[36:37], v45 offset:61440
    ds_read_b64_tr_b16 v[38:39], v45 offset:62464
    s_waitcnt lgkmcnt(7)
    v_mfma_f32_32x32x16_bf16 v[64:79], v[16:19], v[52:55], v[64:79]
    v_dot2_f32_bf16 v4, v52, s40, v4
    v_dot2_f32_bf16 v4, v53, s40, v4
    v_dot2_f32_bf16 v4, v54, s40, v4
    v_dot2_f32_bf16 v4, v55, s40, v4
    v_mfma_f32_32x32x16_bf16 v[80:95], v[20:23], v[52:55], v[80:95]
    v_dot2_f32_bf16 v5, v52, v52, v5
    v_dot2_f32_bf16 v5, v53, v53, v5
    v_dot2_f32_bf16 v5, v54, v54, v5
    v_dot2_f32_bf16 v5, v55, v55, v5
    v_mfma_f32_32x32x16_bf16 v[96:111], v[52:55], v[24:27], v[96:111]
    s_waitcnt lgkmcnt(0)
    v_mfma_f32_32x32x16_bf16 v[64:79], v[28:31], v[56:59], v[64:79]
    v_dot2_f32_bf16 v4, v56, s40, v4
    v_dot2_f32_bf16 v4, v57, s40, v4
    v_dot2_f32_bf16 v4, v58, s40, v4
    v_dot2_f32_bf16 v4, v59, s40, v4
    v_mfma_f32_32x32x16_bf16 v[80:95], v[32:35], v[56:59], v[80:95]
    v_dot2_f32_bf16 v5, v56, v56, v5
    v_dot2_f32_bf16 v5, v57, v57, v5
    v_dot2_f32_bf16 v5, v58, v58, v5
    v_dot2_f32_bf16 v5, v59, v59, v5
    v_mfma_f32_32x32x16_bf16 v[96:111], v[56:59], v[36:39], v[96:111]
    s_nop 15
    s_barrier
    v_mov_b32 v9, v4
    s_nop 1
    v_permlane32_swap_b32 v4, v9
    s_nop 1
    v_add_f32 v4, v4, v9
    v_mov_b32 v9, v5
    s_nop 1
    v_permlane32_swap_b32 v5, v9
    s_nop 1
    v_add_f32 v5, v5, v9
    v_mul_f32 v4, 0x3b000000, v4
    v_mul_f32 v5, 0x3b000000, v5
    v_fma_f32 v5, -v4, v4, v5
    v_max_f32 v5, 0, v5
    v_cvt_pk_bf16_f32 v9, v4, v4
    v_lshlrev_b32 v4, 16, v9
    v_cvt_pk_bf16_f32 v9, v5, v5
    v_lshlrev_b32 v5, 16, v9
    v_add_f32 v5, 0x3727c5ac, v5
    v_cvt_pk_bf16_f32 v9, v5, v5
    v_lshlrev_b32 v5, 16, v9
    v_sqrt_f32 v5, v5
    s_nop 0
    v_cvt_pk_bf16_f32 v9, v5, v5
    v_lshlrev_b32 v5, 16, v9
    v_rcp_f32 v5, v5
    s_nop 0
    v_sub_f32 v46, 0, v4
    v_mov_b32 v47, v46
    v_mov_b32 v48, v5
    v_mov_b32 v49, v5
    v_and_b32 v9, 31, v1
    v_lshlrev_b32 v9, 2, v9
    v_add_u32 v10, 133120, v9
    ds_read_b32 v112, v10 offset:0
    ds_read_b32 v113, v10 offset:128
    ds_read_b32 v114, v10 offset:256
    ds_read_b32 v115, v10 offset:384
    ds_read_b32 v116, v10 offset:512
    ds_read_b32 v117, v10 offset:640
    ds_read_b32 v118, v10 offset:768
    ds_read_b32 v119, v10 offset:896
    ds_read_b32 v120, v10 offset:1024
    ds_read_b32 v121, v10 offset:1152
    ds_read_b32 v122, v10 offset:1280
    ds_read_b32 v123, v10 offset:1408
    ds_read_b32 v124, v10 offset:1536
    ds_read_b32 v125, v10 offset:1664
    ds_read_b32 v126, v10 offset:1792
    ds_read_b32 v127, v10 offset:1920
    ds_read_b32 v128, v10 offset:2048
    ds_read_b32 v129, v10 offset:2176
    ds_read_b32 v130, v10 offset:2304
    ds_read_b32 v131, v10 offset:2432
    ds_read_b32 v132, v10 offset:2560
    ds_read_b32 v133, v10 offset:2688
    ds_read_b32 v134, v10 offset:2816
    ds_read_b32 v135, v10 offset:2944
    s_waitcnt lgkmcnt(0)
    v_add_f32 v6, v112, v115
    v_add_f32 v6, v6, v118
    v_add_f32 v6, v6, v121
    v_add_f32 v6, v6, v124
    v_add_f32 v6, v6, v127
    v_add_f32 v6, v6, v130
    v_add_f32 v6, v6, v133
    v_add_f32 v7, v113, v116
    v_add_f32 v7, v7, v119
    v_add_f32 v7, v7, v122
    v_add_f32 v7, v7, v125
    v_add_f32 v7, v7, v128
    v_add_f32 v7, v7, v131
    v_add_f32 v7, v7, v134
    v_add_f32 v8, v114, v117
    v_add_f32 v8, v8, v120
    v_add_f32 v8, v8, v123
    v_add_f32 v8, v8, v126
    v_add_f32 v8, v8, v129
    v_add_f32 v8, v8, v132
    v_add_f32 v8, v8, v135
    s_lshl_b32 s47, s48, 9
    s_add_u32 s47, s47, 131072
    v_add_u32 v10, s47, v9
    ds_write_b32 v10, v6 offset:0
    ds_write_b32 v10, v7 offset:128
    ds_write_b32 v10, v4 offset:256
    ds_write_b32 v10, v5 offset:384
    v_lshlrev_b32 v10, 4, v13
    v_add_u32 v10, s47, v10
    s_waitcnt lgkmcnt(0)
    ds_read_b128 v[112:115], v10 offset:0
    ds_read_b128 v[116:119], v10 offset:32
    ds_read_b128 v[120:123], v10 offset:64
    ds_read_b128 v[124:127], v10 offset:96
    ds_read_b128 v[128:131], v10 offset:128
    ds_read_b128 v[132:135], v10 offset:160
    ds_read_b128 v[136:139], v10 offset:192
    ds_read_b128 v[140:143], v10 offset:224
    s_waitcnt lgkmcnt(0)
    v_pk_fma_f32 v[64:65], v[112:113], v[46:47], v[64:65]
    v_pk_mul_f32 v[64:65], v[64:65], v[48:49]
    v_pk_fma_f32 v[66:67], v[114:115], v[46:47], v[66:67]
    v_pk_mul_f32 v[66:67], v[66:67], v[48:49]
    v_pk_fma_f32 v[68:69], v[116:117], v[46:47], v[68:69]
    v_pk_mul_f32 v[68:69], v[68:69], v[48:49]
    v_pk_fma_f32 v[70:71], v[118:119], v[46:47], v[70:71]
    v_pk_mul_f32 v[70:71], v[70:71], v[48:49]
    v_pk_fma_f32 v[72:73], v[120:121], v[46:47], v[72:73]
    v_pk_mul_f32 v[72:73], v[72:73], v[48:49]
    v_pk_fma_f32 v[74:75], v[122:123], v[46:47], v[74:75]
    v_pk_mul_f32 v[74:75], v[74:75], v[48:49]
    v_pk_fma_f32 v[76:77], v[124:125], v[46:47], v[76:77]
    v_pk_mul_f32 v[76:77], v[76:77], v[48:49]
    v_pk_fma_f32 v[78:79], v[126:127], v[46:47], v[78:79]
    v_pk_mul_f32 v[78:79], v[78:79], v[48:49]
    v_cvt_pk_bf16_f32 v64, v64, v65
    v_cvt_pk_bf16_f32 v65, v66, v67
    v_cvt_pk_bf16_f32 v66, v68, v69
    v_cvt_pk_bf16_f32 v67, v70, v71
    v_cvt_pk_bf16_f32 v68, v72, v73
    v_cvt_pk_bf16_f32 v69, v74, v75
    v_cvt_pk_bf16_f32 v70, v76, v77
    v_cvt_pk_bf16_f32 v71, v78, v79
    s_nop 1
    v_permlane32_swap_b32 v64, v66
    v_permlane32_swap_b32 v65, v67
    v_permlane32_swap_b32 v68, v70
    v_permlane32_swap_b32 v69, v71
    s_nop 1
    v_lshlrev_b32 v11, 5, v14
    v_lshlrev_b32 v12, 4, v13
    v_add_u32 v11, v11, v12
    s_lshl_b32 s36, s25, 2
    s_add_u32 s36, s36, 0
    s_lshl_b32 s36, s36, 16
    s_add_u32 s37, s36, 65536
    buffer_store_dwordx4 v[64:67], v11, s[20:23], s36 offen
    buffer_store_dwordx4 v[68:71], v11, s[20:23], s37 offen
    v_pk_fma_f32 v[80:81], v[128:129], v[46:47], v[80:81]
    v_pk_mul_f32 v[80:81], v[80:81], v[48:49]
    v_pk_fma_f32 v[82:83], v[130:131], v[46:47], v[82:83]
    v_pk_mul_f32 v[82:83], v[82:83], v[48:49]
    v_pk_fma_f32 v[84:85], v[132:133], v[46:47], v[84:85]
    v_pk_mul_f32 v[84:85], v[84:85], v[48:49]
    v_pk_fma_f32 v[86:87], v[134:135], v[46:47], v[86:87]
    v_pk_mul_f32 v[86:87], v[86:87], v[48:49]
    v_pk_fma_f32 v[88:89], v[136:137], v[46:47], v[88:89]
    v_pk_mul_f32 v[88:89], v[88:89], v[48:49]
    v_pk_fma_f32 v[90:91], v[138:139], v[46:47], v[90:91]
    v_pk_mul_f32 v[90:91], v[90:91], v[48:49]
    v_pk_fma_f32 v[92:93], v[140:141], v[46:47], v[92:93]
    v_pk_mul_f32 v[92:93], v[92:93], v[48:49]
    v_pk_fma_f32 v[94:95], v[142:143], v[46:47], v[94:95]
    v_pk_mul_f32 v[94:95], v[94:95], v[48:49]
    v_cvt_pk_bf16_f32 v80, v80, v81
    v_cvt_pk_bf16_f32 v81, v82, v83
    v_cvt_pk_bf16_f32 v82, v84, v85
    v_cvt_pk_bf16_f32 v83, v86, v87
    v_cvt_pk_bf16_f32 v84, v88, v89
    v_cvt_pk_bf16_f32 v85, v90, v91
    v_cvt_pk_bf16_f32 v86, v92, v93
    v_cvt_pk_bf16_f32 v87, v94, v95
    s_nop 1
    v_permlane32_swap_b32 v80, v82
    v_permlane32_swap_b32 v81, v83
    v_permlane32_swap_b32 v84, v86
    v_permlane32_swap_b32 v85, v87
    s_nop 1
    s_lshl_b32 s36, s25, 2
    s_add_u32 s36, s36, 2
    s_lshl_b32 s36, s36, 16
    s_add_u32 s37, s36, 65536
    buffer_store_dwordx4 v[80:83], v11, s[20:23], s36 offen
    buffer_store_dwordx4 v[84:87], v11, s[20:23], s37 offen
    ds_read_b128 v[112:115], v10 offset:256
    ds_read_b128 v[128:131], v10 offset:384
    ds_read_b128 v[116:119], v10 offset:288
    ds_read_b128 v[132:135], v10 offset:416
    ds_read_b128 v[120:123], v10 offset:320
    ds_read_b128 v[136:139], v10 offset:448
    ds_read_b128 v[124:127], v10 offset:352
    ds_read_b128 v[140:143], v10 offset:480
    s_waitcnt lgkmcnt(0)
    v_fma_f32 v96, -v112, v8, v96
    v_mul_f32 v96, v128, v96
    v_fma_f32 v97, -v113, v8, v97
    v_mul_f32 v97, v129, v97
    v_fma_f32 v98, -v114, v8, v98
    v_mul_f32 v98, v130, v98
    v_fma_f32 v99, -v115, v8, v99
    v_mul_f32 v99, v131, v99
    v_fma_f32 v100, -v116, v8, v100
    v_mul_f32 v100, v132, v100
    v_fma_f32 v101, -v117, v8, v101
    v_mul_f32 v101, v133, v101
    v_fma_f32 v102, -v118, v8, v102
    v_mul_f32 v102, v134, v102
    v_fma_f32 v103, -v119, v8, v103
    v_mul_f32 v103, v135, v103
    v_fma_f32 v104, -v120, v8, v104
    v_mul_f32 v104, v136, v104
    v_fma_f32 v105, -v121, v8, v105
    v_mul_f32 v105, v137, v105
    v_fma_f32 v106, -v122, v8, v106
    v_mul_f32 v106, v138, v106
    v_fma_f32 v107, -v123, v8, v107
    v_mul_f32 v107, v139, v107
    v_fma_f32 v108, -v124, v8, v108
    v_mul_f32 v108, v140, v108
    v_fma_f32 v109, -v125, v8, v109
    v_mul_f32 v109, v141, v109
    v_fma_f32 v110, -v126, v8, v110
    v_mul_f32 v110, v142, v110
    v_fma_f32 v111, -v127, v8, v111
    v_mul_f32 v111, v143, v111
    v_cvt_pk_bf16_f32 v96, v96, v97
    v_cvt_pk_bf16_f32 v97, v98, v99
    v_cvt_pk_bf16_f32 v98, v100, v101
    v_cvt_pk_bf16_f32 v99, v102, v103
    v_cvt_pk_bf16_f32 v100, v104, v105
    v_cvt_pk_bf16_f32 v101, v106, v107
    v_cvt_pk_bf16_f32 v102, v108, v109
    v_cvt_pk_bf16_f32 v103, v110, v111
    v_and_b32 v11, 15, v1
    v_lshlrev_b32 v11, 5, v11
    v_lshlrev_b32 v12, 4, v13
    v_add_u32 v11, v11, v12
    v_bfe_u32 v12, v1, 4, 1
    v_lshlrev_b32 v12, 16, v12
    v_add_u32 v11, v11, v12
    s_lshl_b32 s36, s25, 17
    s_lshl_b32 s37, s27, 5
    s_add_u32 s36, s36, s37
    s_add_u32 s36, s36, 4194304
    buffer_store_dwordx4 v[96:99], v11, s[20:23], s36 offen
    buffer_store_dwordx4 v[100:103], v11, s[20:23], s36 offen offset:512
    s_waitcnt vmcnt(0)
L_kqkv_kernel_end:
    s_endpgm
.globl kattn_kernel
.p2align 8
.type kattn_kernel,@function
kattn_kernel:
    s_cmp_ge_u32 s2, 256
    s_cbranch_scc1 L_kattn_kernel_end
    s_load_dwordx2 s[8:9], s[0:1], 64
    s_and_b32 s24, s2, 7
    s_lshl_b32 s24, s24, 2
    s_lshr_b32 s25, s2, 3
    s_and_b32 s26, s25, 3
    s_add_u32 s24, s24, s26
    s_lshr_b32 s25, s2, 5
    v_and_b32 v1, 63, v0
    v_lshrrev_b32 v3, 6, v0
    s_nop 0
    v_readfirstlane_b32 s26, v3
    v_lshrrev_b32 v2, 5, v1
    s_lshl_b32 s27, s25, 3
    s_add_u32 s27, s27, s26
    s_mov_b32 s29, s27
    s_lshl_b32 s27, s27, 5
    s_waitcnt lgkmcnt(0)
    s_lshl_b32 s28, s24, 16
    s_add_u32 s12, s8, s28
    s_addc_u32 s13, s9, 0
    s_and_b32 s13, s13, 0xffff
    s_mov_b32 s14, 65536
    s_mov_b32 s15, 0x00020000
    s_add_u32 s16, s12, 2097152
    s_addc_u32 s17, s13, 0
    s_and_b32 s17, s17, 0xffff
    s_mov_b32 s18, 65536
    s_mov_b32 s19, 0x00020000
    s_add_u32 s20, s12, 4194304
    s_addc_u32 s21, s13, 0
    s_and_b32 s21, s21, 0xffff
    s_mov_b32 s22, 65536
    s_mov_b32 s23, 0x00020000
    s_add_u32 s32, s8, 8388608
    s_addc_u32 s33, s9, 0
    s_and_b32 s33, s33, 0xffff
    s_mov_b32 s34, 2097152
    s_mov_b32 s35, 0x00020000
    v_lshlrev_b32 v3, 4, v1
    s_lshl_b32 s30, s25, 13
    s_sub_u32 s30, s30, 8192
    s_lshl_b32 s31, s26, 11
    s_add_u32 s30, s30, s31
    v_add_u32 v4, s30, v3
    v_add_u32 v5, 1024, v4
    s_mov_b32 m0, s31
    s_nop 0
    buffer_load_dwordx4 v4, s[16:19], 0 offen lds
    s_add_u32 s36, s31, 1024
    s_mov_b32 m0, s36
    s_nop 0
    buffer_load_dwordx4 v5, s[16:19], 0 offen lds
    s_add_u32 s36, s31, 16384
    s_mov_b32 m0, s36
    s_nop 0
    buffer_load_dwordx4 v4, s[20:23], 0 offen lds
    s_add_u32 s36, s31, 17408
    s_mov_b32 m0, s36
    s_nop 0
    buffer_load_dwordx4 v5, s[20:23], 0 offen lds
    v_and_b32 v3, 31, v1
    v_add_u32 v12, s27, v3
    v_lshlrev_b32 v7, 5, v12
    v_lshlrev_b32 v4, 4, v2
    v_add_u32 v7, v7, v4
    buffer_load_dwordx4 v[16:19], v7, s[12:15], 0 offen
    s_load_dwordx2 s[40:41], s[0:1], 16
    s_load_dwordx4 s[44:47], s[0:1], 32
    s_lshl_b32 s38, s2, 3
    s_add_u32 s38, s38, s26
    s_lshl_b32 s38, s38, 10
    v_lshlrev_b32 v6, 4, v1
    s_waitcnt lgkmcnt(0)
    s_mov_b32 s48, s40
    s_and_b32 s49, s41, 0xffff
    s_mov_b32 s50, 524288
    s_mov_b32 s51, 0x00020000
    buffer_load_dwordx4 v[240:243], v6, s[48:51], s38 offen
    s_mov_b32 s48, s44
    s_and_b32 s49, s45, 0xffff
    s_mov_b32 s50, 1409024
    s_mov_b32 s51, 0x00020000
    buffer_load_dwordx4 v[240:243], v6, s[48:51], s38 offen
    s_mov_b32 s48, s46
    s_and_b32 s49, s47, 0xffff
    s_mov_b32 s50, 1409024
    s_mov_b32 s51, 0x00020000
    buffer_load_dwordx4 v[240:243], v6, s[48:51], s38 offen
    v_lshlrev_b32 v8, 5, v3
    v_add_u32 v8, v8, v4
    s_lshl_b32 s36, s26, 10
    v_add_u32 v8, s36, v8
    v_and_b32 v3, 15, v1
    v_lshlrev_b32 v9, 5, v3
    v_add_u32 v9, v9, v4
    s_add_u32 s36, s36, 16384
    v_add_u32 v9, s36, v9
    v_and_b32 v3, 16, v1
    v_cmp_ne_u32 vcc, 0, v3
    v_mov_b32 v3, 32768
    s_nop 1
    v_cndmask_b32 v9, v9, v3, vcc
    v_mov_b32 v56, 0x3f803f80
    v_mov_b32 v57, 0x3f803f80
    v_mov_b32 v58, 0x3f803f80
    v_mov_b32 v59, 0x3f803f80
    v_lshlrev_b32 v3, 4, v0
    ds_write_b128 v3, v[56:59] offset:32768
    v_cmp_gt_u32 vcc, 128, v0
    s_and_saveexec_b64 s[52:53], vcc
    ds_write_b128 v3, v[56:59] offset:40960
    s_mov_b64 exec, s[52:53]
    s_waitcnt lgkmcnt(0)
    s_waitcnt vmcnt(3)
    s_barrier
    ds_read_b128 v[20:23], v8 offset:0
    ds_read_b128 v[24:27], v8 offset:1024
    ds_read_b128 v[28:31], v8 offset:2048
    ds_read_b128 v[32:35], v8 offset:3072
    ds_read_b128 v[36:39], v8 offset:4096
    ds_read_b128 v[40:43], v8 offset:5120
    ds_read_b128 v[44:47], v8 offset:6144
    ds_read_b128 v[48:51], v8 offset:7168
    ds_read_b128 v[52:55], v8 offset:8192
    s_waitcnt lgkmcnt(8)
    v_mfma_f32_32x32x16_bf16 v[56:71], v[20:23], v[16:19], 0
    s_waitcnt lgkmcnt(7)
    v_mfma_f32_32x32x16_bf16 v[72:87], v[24:27], v[16:19], 0
    s_waitcnt lgkmcnt(6)
    v_mfma_f32_32x32x16_bf16 v[88:103], v[28:31], v[16:19], 0
    s_waitcnt lgkmcnt(5)
    v_mfma_f32_32x32x16_bf16 v[104:119], v[32:35], v[16:19], 0
    s_waitcnt lgkmcnt(4)
    v_mfma_f32_32x32x16_bf16 v[120:135], v[36:39], v[16:19], 0
    s_waitcnt lgkmcnt(3)
    v_mfma_f32_32x32x16_bf16 v[136:151], v[40:43], v[16:19], 0
    s_waitcnt lgkmcnt(2)
    v_mfma_f32_32x32x16_bf16 v[152:167], v[44:47], v[16:19], 0
    s_waitcnt lgkmcnt(1)
    v_mfma_f32_32x32x16_bf16 v[168:183], v[48:51], v[16:19], 0
    s_waitcnt lgkmcnt(0)
    v_mfma_f32_32x32x16_bf16 v[184:199], v[52:55], v[16:19], 0
    ds_read_b128 v[200:203], v9 offset:0
    ds_read_b128 v[204:207], v9 offset:512
    ds_read_b128 v[208:211], v9 offset:1024
    ds_read_b128 v[212:215], v9 offset:1536
    ds_read_b128 v[216:219], v9 offset:2048
    ds_read_b128 v[220:223], v9 offset:2560
    ds_read_b128 v[224:227], v9 offset:3072
    ds_read_b128 v[228:231], v9 offset:3584
    s_nop 15
    v_and_b32 v3, 31, v1
    v_lshlrev_b32 v4, 2, v2
    v_sub_u32 v3, v3, v4
    v_mov_b32 v5, 0xff800000
    v_cmp_gt_i32 vcc, 0, v3
    s_nop 1
    v_cndmask_b32 v56, v5, v56, vcc
    v_cndmask_b32 v184, v184, v5, vcc
    v_cmp_gt_i32 vcc, 1, v3
    s_nop 1
    v_cndmask_b32 v57, v5, v57, vcc
    v_cndmask_b32 v185, v185, v5, vcc
    v_cmp_gt_i32 vcc, 2, v3
    s_nop 1
    v_cndmask_b32 v58, v5, v58, vcc
    v_cndmask_b32 v186, v186, v5, vcc
    v_cmp_gt_i32 vcc, 3, v3
    s_nop 1
    v_cndmask_b32 v59, v5, v59, vcc
    v_cndmask_b32 v187, v187, v5, vcc
    v_cmp_gt_i32 vcc, 8, v3
    s_nop 1
    v_cndmask_b32 v60, v5, v60, vcc
    v_cndmask_b32 v188, v188, v5, vcc
    v_cmp_gt_i32 vcc, 9, v3
    s_nop 1
    v_cndmask_b32 v61, v5, v61, vcc
    v_cndmask_b32 v189, v189, v5, vcc
    v_cmp_gt_i32 vcc, 10, v3
    s_nop 1
    v_cndmask_b32 v62, v5, v62, vcc
    v_cndmask_b32 v190, v190, v5, vcc
    v_cmp_gt_i32 vcc, 11, v3
    s_nop 1
    v_cndmask_b32 v63, v5, v63, vcc
    v_cndmask_b32 v191, v191, v5, vcc
    v_cmp_gt_i32 vcc, 16, v3
    s_nop 1
    v_cndmask_b32 v64, v5, v64, vcc
    v_cndmask_b32 v192, v192, v5, vcc
    v_cmp_gt_i32 vcc, 17, v3
    s_nop 1
    v_cndmask_b32 v65, v5, v65, vcc
    v_cndmask_b32 v193, v193, v5, vcc
    v_cmp_gt_i32 vcc, 18, v3
    s_nop 1
    v_cndmask_b32 v66, v5, v66, vcc
    v_cndmask_b32 v194, v194, v5, vcc
    v_cmp_gt_i32 vcc, 19, v3
    s_nop 1
    v_cndmask_b32 v67, v5, v67, vcc
    v_cndmask_b32 v195, v195, v5, vcc
    v_cmp_gt_i32 vcc, 24, v3
    s_nop 1
    v_cndmask_b32 v68, v5, v68, vcc
    v_cndmask_b32 v196, v196, v5, vcc
    v_cmp_gt_i32 vcc, 25, v3
    s_nop 1
    v_cndmask_b32 v69, v5, v69, vcc
    v_cndmask_b32 v197, v197, v5, vcc
    v_cmp_gt_i32 vcc, 26, v3
    s_nop 1
    v_cndmask_b32 v70, v5, v70, vcc
    v_cndmask_b32 v198, v198, v5, vcc
    v_cmp_gt_i32 vcc, 27, v3
    s_nop 1
    v_cndmask_b32 v71, v5, v71, vcc
    v_cndmask_b32 v199, v199, v5, vcc
    s_cmp_ge_u32 s29, 8
    s_cbranch_scc1 L_kattn_kernel_allok
    s_cmp_ge_u32 s29, 8
    s_cbranch_scc1 L_kattn_kernel_ok0
    v_mov_b32 v56, v5
    v_mov_b32 v57, v5
    v_mov_b32 v58, v5
    v_mov_b32 v59, v5
    v_mov_b32 v60, v5
    v_mov_b32 v61, v5
    v_mov_b32 v62, v5
    v_mov_b32 v63, v5
    v_mov_b32 v64, v5
    v_mov_b32 v65, v5
    v_mov_b32 v66, v5
    v_mov_b32 v67, v5
    v_mov_b32 v68, v5
    v_mov_b32 v69, v5
    v_mov_b32 v70, v5
    v_mov_b32 v71, v5
L_kattn_kernel_ok0:
    s_cmp_ge_u32 s29, 7
    s_cbranch_scc1 L_kattn_kernel_ok1
    v_mov_b32 v72, v5
    v_mov_b32 v73, v5
    v_mov_b32 v74, v5
    v_mov_b32 v75, v5
    v_mov_b32 v76, v5
    v_mov_b32 v77, v5
    v_mov_b32 v78, v5
    v_mov_b32 v79, v5
    v_mov_b32 v80, v5
    v_mov_b32 v81, v5
    v_mov_b32 v82, v5
    v_mov_b32 v83, v5
    v_mov_b32 v84, v5
    v_mov_b32 v85, v5
    v_mov_b32 v86, v5
    v_mov_b32 v87, v5
L_kattn_kernel_ok1:
    s_cmp_ge_u32 s29, 6
    s_cbranch_scc1 L_kattn_kernel_ok2
    v_mov_b32 v88, v5
    v_mov_b32 v89, v5
    v_mov_b32 v90, v5
    v_mov_b32 v91, v5
    v_mov_b32 v92, v5
    v_mov_b32 v93, v5
    v_mov_b32 v94, v5
    v_mov_b32 v95, v5
    v_mov_b32 v96, v5
    v_mov_b32 v97, v5
    v_mov_b32 v98, v5
    v_mov_b32 v99, v5
    v_mov_b32 v100, v5
    v_mov_b32 v101, v5
    v_mov_b32 v102, v5
    v_mov_b32 v103, v5
L_kattn_kernel_ok2:
    s_cmp_ge_u32 s29, 5
    s_cbranch_scc1 L_kattn_kernel_ok3
    v_mov_b32 v104, v5
    v_mov_b32 v105, v5
    v_mov_b32 v106, v5
    v_mov_b32 v107, v5
    v_mov_b32 v108, v5
    v_mov_b32 v109, v5
    v_mov_b32 v110, v5
    v_mov_b32 v111, v5
    v_mov_b32 v112, v5
    v_mov_b32 v113, v5
    v_mov_b32 v114, v5
    v_mov_b32 v115, v5
    v_mov_b32 v116, v5
    v_mov_b32 v117, v5
    v_mov_b32 v118, v5
    v_mov_b32 v119, v5
L_kattn_kernel_ok3:
    s_cmp_ge_u32 s29, 4
    s_cbranch_scc1 L_kattn_kernel_ok4
    v_mov_b32 v120, v5
    v_mov_b32 v121, v5
    v_mov_b32 v122, v5
    v_mov_b32 v123, v5
    v_mov_b32 v124, v5
    v_mov_b32 v125, v5
    v_mov_b32 v126, v5
    v_mov_b32 v127, v5
    v_mov_b32 v128, v5
    v_mov_b32 v129, v5
    v_mov_b32 v130, v5
    v_mov_b32 v131, v5
    v_mov_b32 v132, v5
    v_mov_b32 v133, v5
    v_mov_b32 v134, v5
    v_mov_b32 v135, v5
L_kattn_kernel_ok4:
    s_cmp_ge_u32 s29, 3
    s_cbranch_scc1 L_kattn_kernel_ok5
    v_mov_b32 v136, v5
    v_mov_b32 v137, v5
    v_mov_b32 v138, v5
    v_mov_b32 v139, v5
    v_mov_b32 v140, v5
    v_mov_b32 v141, v5
    v_mov_b32 v142, v5
    v_mov_b32 v143, v5
    v_mov_b32 v144, v5
    v_mov_b32 v145, v5
    v_mov_b32 v146, v5
    v_mov_b32 v147, v5
    v_mov_b32 v148, v5
    v_mov_b32 v149, v5
    v_mov_b32 v150, v5
    v_mov_b32 v151, v5
L_kattn_kernel_ok5:
    s_cmp_ge_u32 s29, 2
    s_cbranch_scc1 L_kattn_kernel_ok6
    v_mov_b32 v152, v5
    v_mov_b32 v153, v5
    v_mov_b32 v154, v5
    v_mov_b32 v155, v5
    v_mov_b32 v156, v5
    v_mov_b32 v157, v5
    v_mov_b32 v158, v5
    v_mov_b32 v159, v5
    v_mov_b32 v160, v5
    v_mov_b32 v161, v5
    v_mov_b32 v162, v5
    v_mov_b32 v163, v5
    v_mov_b32 v164, v5
    v_mov_b32 v165, v5
    v_mov_b32 v166, v5
    v_mov_b32 v167, v5
L_kattn_kernel_ok6:
    s_cmp_ge_u32 s29, 1
    s_cbranch_scc1 L_kattn_kernel_ok7
    v_mov_b32 v168, v5
    v_mov_b32 v169, v5
    v_mov_b32 v170, v5
    v_mov_b32 v171, v5
    v_mov_b32 v172, v5
    v_mov_b32 v173, v5
    v_mov_b32 v174, v5
    v_mov_b32 v175, v5
    v_mov_b32 v176, v5
    v_mov_b32 v177, v5
    v_mov_b32 v178, v5
    v_mov_b32 v179, v5
    v_mov_b32 v180, v5
    v_mov_b32 v181, v5
    v_mov_b32 v182, v5
    v_mov_b32 v183, v5
L_kattn_kernel_ok7:
L_kattn_kernel_allok:
    v_max3_f32 v10, v56, v57, v58
    v_max3_f32 v10, v10, v59, v60
    v_max3_f32 v10, v10, v61, v62
    v_max3_f32 v10, v10, v63, v64
    v_max3_f32 v10, v10, v65, v66
    v_max3_f32 v10, v10, v67, v68
    v_max3_f32 v10, v10, v69, v70
    v_max3_f32 v10, v10, v71, v72
    v_max3_f32 v10, v10, v73, v74
    v_max3_f32 v10, v10, v75, v76
    v_max3_f32 v10, v10, v77, v78
    v_max3_f32 v10, v10, v79, v80
    v_max3_f32 v10, v10, v81, v82
    v_max3_f32 v10, v10, v83, v84
    v_max3_f32 v10, v10, v85, v86
    v_max3_f32 v10, v10, v87, v88
    v_max3_f32 v10, v10, v89, v90
    v_max3_f32 v10, v10, v91, v92
    v_max3_f32 v10, v10, v93, v94
    v_max3_f32 v10, v10, v95, v96
    v_max3_f32 v10, v10, v97, v98
    v_max3_f32 v10, v10, v99, v100
    v_max3_f32 v10, v10, v101, v102
    v_max3_f32 v10, v10, v103, v104
    v_max3_f32 v10, v10, v105, v106
    v_max3_f32 v10, v10, v107, v108
    v_max3_f32 v10, v10, v109, v110
    v_max3_f32 v10, v10, v111, v112
    v_max3_f32 v10, v10, v113, v114
    v_max3_f32 v10, v10, v115, v116
    v_max3_f32 v10, v10, v117, v118
    v_max3_f32 v10, v10, v119, v120
    v_max3_f32 v10, v10, v121, v122
    v_max3_f32 v10, v10, v123, v124
    v_max3_f32 v10, v10, v125, v126
    v_max3_f32 v10, v10, v127, v128
    v_max3_f32 v10, v10, v129, v130
    v_max3_f32 v10, v10, v131, v132
    v_max3_f32 v10, v10, v133, v134
    v_max3_f32 v10, v10, v135, v136
    v_max3_f32 v10, v10, v137, v138
    v_max3_f32 v10, v10, v139, v140
    v_max3_f32 v10, v10, v141, v142
    v_max3_f32 v10, v10, v143, v144
    v_max3_f32 v10, v10, v145, v146
    v_max3_f32 v10, v10, v147, v148
    v_max3_f32 v10, v10, v149, v150
    v_max3_f32 v10, v10, v151, v152
    v_max3_f32 v10, v10, v153, v154
    v_max3_f32 v10, v10, v155, v156
    v_max3_f32 v10, v10, v157, v158
    v_max3_f32 v10, v10, v159, v160
    v_max3_f32 v10, v10, v161, v162
    v_max3_f32 v10, v10, v163, v164
    v_max3_f32 v10, v10, v165, v166
    v_max3_f32 v10, v10, v167, v168
    v_max3_f32 v10, v10, v169, v170
    v_max3_f32 v10, v10, v171, v172
    v_max3_f32 v10, v10, v173, v174
    v_max3_f32 v10, v10, v175, v176
    v_max3_f32 v10, v10, v177, v178
    v_max3_f32 v10, v10, v179, v180
    v_max3_f32 v10, v10, v181, v182
    v_max3_f32 v10, v10, v183, v184
    v_max3_f32 v10, v10, v185, v186
    v_max3_f32 v10, v10, v187, v188
    v_max3_f32 v10, v10, v189, v190
    v_max3_f32 v10, v10, v191, v192
    v_max3_f32 v10, v10, v193, v194
    v_max3_f32 v10, v10, v195, v196
    v_max3_f32 v10, v10, v197, v198
    v_max_f32 v10, v10, v199
    v_mov_b32 v3, v10
    s_nop 1
    v_permlane32_swap_b32 v10, v3
    s_nop 1
    v_max_f32 v10, v10, v3
    s_mov_b32 s30, 0x3eb8aa3b
    v_mul_f32 v10, s30, v10
    v_mov_b32 v11, 0
    v_fma_f32 v56, v56, s30, -v10
    v_exp_f32 v56, v56
    v_fma_f32 v57, v57, s30, -v10
    v_exp_f32 v57, v57
    v_fma_f32 v58, v58, s30, -v10
    v_exp_f32 v58, v58
    v_fma_f32 v59, v59, s30, -v10
    v_exp_f32 v59, v59
    v_fma_f32 v60, v60, s30, -v10
    v_exp_f32 v60, v60
    v_fma_f32 v61, v61, s30, -v10
    v_exp_f32 v61, v61
    v_fma_f32 v62, v62, s30, -v10
    v_exp_f32 v62, v62
    v_fma_f32 v63, v63, s30, -v10
    v_exp_f32 v63, v63
    v_fma_f32 v64, v64, s30, -v10
    v_exp_f32 v64, v64
    v_fma_f32 v65, v65, s30, -v10
    v_exp_f32 v65, v65
    v_fma_f32 v66, v66, s30, -v10
    v_exp_f32 v66, v66
    v_fma_f32 v67, v67, s30, -v10
    v_exp_f32 v67, v67
    v_fma_f32 v68, v68, s30, -v10
    v_exp_f32 v68, v68
    v_fma_f32 v69, v69, s30, -v10
    v_exp_f32 v69, v69
    v_fma_f32 v70, v70, s30, -v10
    v_exp_f32 v70, v70
    v_fma_f32 v71, v71, s30, -v10
    v_exp_f32 v71, v71
    v_fma_f32 v72, v72, s30, -v10
    v_exp_f32 v72, v72
    v_fma_f32 v73, v73, s30, -v10
    v_exp_f32 v73, v73
    v_fma_f32 v74, v74, s30, -v10
    v_exp_f32 v74, v74
    v_fma_f32 v75, v75, s30, -v10
    v_exp_f32 v75, v75
    v_fma_f32 v76, v76, s30, -v10
    v_exp_f32 v76, v76
    v_fma_f32 v77, v77, s30, -v10
    v_exp_f32 v77, v77
    v_fma_f32 v78, v78, s30, -v10
    v_exp_f32 v78, v78
    v_fma_f32 v79, v79, s30, -v10
    v_exp_f32 v79, v79
    v_fma_f32 v80, v80, s30, -v10
    v_exp_f32 v80, v80
    v_fma_f32 v81, v81, s30, -v10
    v_exp_f32 v81, v81
    v_fma_f32 v82, v82, s30, -v10
    v_exp_f32 v82, v82
    v_fma_f32 v83, v83, s30, -v10
    v_exp_f32 v83, v83
    v_fma_f32 v84, v84, s30, -v10
    v_exp_f32 v84, v84
    v_fma_f32 v85, v85, s30, -v10
    v_exp_f32 v85, v85
    v_fma_f32 v86, v86, s30, -v10
    v_exp_f32 v86, v86
    v_fma_f32 v87, v87, s30, -v10
    v_exp_f32 v87, v87
    v_fma_f32 v88, v88, s30, -v10
    v_exp_f32 v88, v88
    v_fma_f32 v89, v89, s30, -v10
    v_exp_f32 v89, v89
    v_fma_f32 v90, v90, s30, -v10
    v_exp_f32 v90, v90
    v_fma_f32 v91, v91, s30, -v10
    v_exp_f32 v91, v91
    v_fma_f32 v92, v92, s30, -v10
    v_exp_f32 v92, v92
    v_fma_f32 v93, v93, s30, -v10
    v_exp_f32 v93, v93
    v_fma_f32 v94, v94, s30, -v10
    v_exp_f32 v94, v94
    v_fma_f32 v95, v95, s30, -v10
    v_exp_f32 v95, v95
    v_fma_f32 v96, v96, s30, -v10
    v_exp_f32 v96, v96
    v_fma_f32 v97, v97, s30, -v10
    v_exp_f32 v97, v97
    v_fma_f32 v98, v98, s30, -v10
    v_exp_f32 v98, v98
    v_fma_f32 v99, v99, s30, -v10
    v_exp_f32 v99, v99
    v_fma_f32 v100, v100, s30, -v10
    v_exp_f32 v100, v100
    v_fma_f32 v101, v101, s30, -v10
    v_exp_f32 v101, v101
    v_fma_f32 v102, v102, s30, -v10
    v_exp_f32 v102, v102
    v_fma_f32 v103, v103, s30, -v10
    v_exp_f32 v103, v103
    v_fma_f32 v104, v104, s30, -v10
    v_exp_f32 v104, v104
    v_fma_f32 v105, v105, s30, -v10
    v_exp_f32 v105, v105
    v_fma_f32 v106, v106, s30, -v10
    v_exp_f32 v106, v106
    v_fma_f32 v107, v107, s30, -v10
    v_exp_f32 v107, v107
    v_fma_f32 v108, v108, s30, -v10
    v_exp_f32 v108, v108
    v_fma_f32 v109, v109, s30, -v10
    v_exp_f32 v109, v109
    v_fma_f32 v110, v110, s30, -v10
    v_exp_f32 v110, v110
    v_fma_f32 v111, v111, s30, -v10
    v_exp_f32 v111, v111
    v_fma_f32 v112, v112, s30, -v10
    v_exp_f32 v112, v112
    v_fma_f32 v113, v113, s30, -v10
    v_exp_f32 v113, v113
    v_fma_f32 v114, v114, s30, -v10
    v_exp_f32 v114, v114
    v_fma_f32 v115, v115, s30, -v10
    v_exp_f32 v115, v115
    v_fma_f32 v116, v116, s30, -v10
    v_exp_f32 v116, v116
    v_fma_f32 v117, v117, s30, -v10
    v_exp_f32 v117, v117
    v_fma_f32 v118, v118, s30, -v10
    v_exp_f32 v118, v118
    v_fma_f32 v119, v119, s30, -v10
    v_exp_f32 v119, v119
    v_fma_f32 v120, v120, s30, -v10
    v_exp_f32 v120, v120
    v_fma_f32 v121, v121, s30, -v10
    v_exp_f32 v121, v121
    v_fma_f32 v122, v122, s30, -v10
    v_exp_f32 v122, v122
    v_fma_f32 v123, v123, s30, -v10
    v_exp_f32 v123, v123
    v_fma_f32 v124, v124, s30, -v10
    v_exp_f32 v124, v124
    v_fma_f32 v125, v125, s30, -v10
    v_exp_f32 v125, v125
    v_fma_f32 v126, v126, s30, -v10
    v_exp_f32 v126, v126
    v_fma_f32 v127, v127, s30, -v10
    v_exp_f32 v127, v127
    v_fma_f32 v128, v128, s30, -v10
    v_exp_f32 v128, v128
    v_fma_f32 v129, v129, s30, -v10
    v_exp_f32 v129, v129
    v_fma_f32 v130, v130, s30, -v10
    v_exp_f32 v130, v130
    v_fma_f32 v131, v131, s30, -v10
    v_exp_f32 v131, v131
    v_fma_f32 v132, v132, s30, -v10
    v_exp_f32 v132, v132
    v_fma_f32 v133, v133, s30, -v10
    v_exp_f32 v133, v133
    v_fma_f32 v134, v134, s30, -v10
    v_exp_f32 v134, v134
    v_fma_f32 v135, v135, s30, -v10
    v_exp_f32 v135, v135
    v_fma_f32 v136, v136, s30, -v10
    v_exp_f32 v136, v136
    v_fma_f32 v137, v137, s30, -v10
    v_exp_f32 v137, v137
    v_fma_f32 v138, v138, s30, -v10
    v_exp_f32 v138, v138
    v_fma_f32 v139, v139, s30, -v10
    v_exp_f32 v139, v139
    v_fma_f32 v140, v140, s30, -v10
    v_exp_f32 v140, v140
    v_fma_f32 v141, v141, s30, -v10
    v_exp_f32 v141, v141
    v_fma_f32 v142, v142, s30, -v10
    v_exp_f32 v142, v142
    v_fma_f32 v143, v143, s30, -v10
    v_exp_f32 v143, v143
    v_fma_f32 v144, v144, s30, -v10
    v_exp_f32 v144, v144
    v_fma_f32 v145, v145, s30, -v10
    v_exp_f32 v145, v145
    v_fma_f32 v146, v146, s30, -v10
    v_exp_f32 v146, v146
    v_fma_f32 v147, v147, s30, -v10
    v_exp_f32 v147, v147
    v_fma_f32 v148, v148, s30, -v10
    v_exp_f32 v148, v148
    v_fma_f32 v149, v149, s30, -v10
    v_exp_f32 v149, v149
    v_fma_f32 v150, v150, s30, -v10
    v_exp_f32 v150, v150
    v_fma_f32 v151, v151, s30, -v10
    v_exp_f32 v151, v151
    v_fma_f32 v152, v152, s30, -v10
    v_exp_f32 v152, v152
    v_fma_f32 v153, v153, s30, -v10
    v_exp_f32 v153, v153
    v_fma_f32 v154, v154, s30, -v10
    v_exp_f32 v154, v154
    v_fma_f32 v155, v155, s30, -v10
    v_exp_f32 v155, v155
    v_fma_f32 v156, v156, s30, -v10
    v_exp_f32 v156, v156
    v_fma_f32 v157, v157, s30, -v10
    v_exp_f32 v157, v157
    v_fma_f32 v158, v158, s30, -v10
    v_exp_f32 v158, v158
    v_fma_f32 v159, v159, s30, -v10
    v_exp_f32 v159, v159
    v_fma_f32 v160, v160, s30, -v10
    v_exp_f32 v160, v160
    v_fma_f32 v161, v161, s30, -v10
    v_exp_f32 v161, v161
    v_fma_f32 v162, v162, s30, -v10
    v_exp_f32 v162, v162
    v_fma_f32 v163, v163, s30, -v10
    v_exp_f32 v163, v163
    v_fma_f32 v164, v164, s30, -v10
    v_exp_f32 v164, v164
    v_fma_f32 v165, v165, s30, -v10
    v_exp_f32 v165, v165
    v_fma_f32 v166, v166, s30, -v10
    v_exp_f32 v166, v166
    v_fma_f32 v167, v167, s30, -v10
    v_exp_f32 v167, v167
    v_fma_f32 v168, v168, s30, -v10
    v_exp_f32 v168, v168
    v_fma_f32 v169, v169, s30, -v10
    v_exp_f32 v169, v169
    v_fma_f32 v170, v170, s30, -v10
    v_exp_f32 v170, v170
    v_fma_f32 v171, v171, s30, -v10
    v_exp_f32 v171, v171
    v_fma_f32 v172, v172, s30, -v10
    v_exp_f32 v172, v172
    v_fma_f32 v173, v173, s30, -v10
    v_exp_f32 v173, v173
    v_fma_f32 v174, v174, s30, -v10
    v_exp_f32 v174, v174
    v_fma_f32 v175, v175, s30, -v10
    v_exp_f32 v175, v175
    v_fma_f32 v176, v176, s30, -v10
    v_exp_f32 v176, v176
    v_fma_f32 v177, v177, s30, -v10
    v_exp_f32 v177, v177
    v_fma_f32 v178, v178, s30, -v10
    v_exp_f32 v178, v178
    v_fma_f32 v179, v179, s30, -v10
    v_exp_f32 v179, v179
    v_fma_f32 v180, v180, s30, -v10
    v_exp_f32 v180, v180
    v_fma_f32 v181, v181, s30, -v10
    v_exp_f32 v181, v181
    v_fma_f32 v182, v182, s30, -v10
    v_exp_f32 v182, v182
    v_fma_f32 v183, v183, s30, -v10
    v_exp_f32 v183, v183
    v_fma_f32 v184, v184, s30, -v10
    v_exp_f32 v184, v184
    v_fma_f32 v185, v185, s30, -v10
    v_exp_f32 v185, v185
    v_fma_f32 v186, v186, s30, -v10
    v_exp_f32 v186, v186
    v_fma_f32 v187, v187, s30, -v10
    v_exp_f32 v187, v187
    v_fma_f32 v188, v188, s30, -v10
    v_exp_f32 v188, v188
    v_fma_f32 v189, v189, s30, -v10
    v_exp_f32 v189, v189
    v_fma_f32 v190, v190, s30, -v10
    v_exp_f32 v190, v190
    v_fma_f32 v191, v191, s30, -v10
    v_exp_f32 v191, v191
    v_fma_f32 v192, v192, s30, -v10
    v_exp_f32 v192, v192
    v_fma_f32 v193, v193, s30, -v10
    v_exp_f32 v193, v193
    v_fma_f32 v194, v194, s30, -v10
    v_exp_f32 v194, v194
    v_fma_f32 v195, v195, s30, -v10
    v_exp_f32 v195, v195
    v_fma_f32 v196, v196, s30, -v10
    v_exp_f32 v196, v196
    v_fma_f32 v197, v197, s30, -v10
    v_exp_f32 v197, v197
    v_fma_f32 v198, v198, s30, -v10
    v_exp_f32 v198, v198
    v_fma_f32 v199, v199, s30, -v10
    v_exp_f32 v199, v199
    v_cvt_pk_bf16_f32 v36, v56, v57
    v_cvt_pk_bf16_f32 v37, v58, v59
    v_cvt_pk_bf16_f32 v38, v60, v61
    v_cvt_pk_bf16_f32 v39, v62, v63
    s_waitcnt lgkmcnt(7)
    s_nop 0
    v_mfma_f32_32x32x16_bf16 v[20:35], v[200:203], v[36:39], 0
    ds_read_b128 v[200:203], v9 offset:4096
    v_cvt_pk_bf16_f32 v40, v64, v65
    v_cvt_pk_bf16_f32 v41, v66, v67
    v_cvt_pk_bf16_f32 v42, v68, v69
    v_cvt_pk_bf16_f32 v43, v70, v71
    s_waitcnt lgkmcnt(7)
    s_nop 0
    v_mfma_f32_32x32x16_bf16 v[20:35], v[204:207], v[40:43], v[20:35]
    ds_read_b128 v[204:207], v9 offset:4608
    v_cvt_pk_bf16_f32 v44, v72, v73
    v_cvt_pk_bf16_f32 v45, v74, v75
    v_cvt_pk_bf16_f32 v46, v76, v77
    v_cvt_pk_bf16_f32 v47, v78, v79
    s_waitcnt lgkmcnt(7)
    s_nop 0
    v_mfma_f32_32x32x16_bf16 v[20:35], v[208:211], v[44:47], v[20:35]
    ds_read_b128 v[208:211], v9 offset:5120
    v_cvt_pk_bf16_f32 v48, v80, v81
    v_cvt_pk_bf16_f32 v49, v82, v83
    v_cvt_pk_bf16_f32 v50, v84, v85
    v_cvt_pk_bf16_f32 v51, v86, v87
    s_waitcnt lgkmcnt(7)
    s_nop 0
    v_mfma_f32_32x32x16_bf16 v[20:35], v[212:215], v[48:51], v[20:35]
    ds_read_b128 v[212:215], v9 offset:5632
    v_cvt_pk_bf16_f32 v36, v88, v89
    v_cvt_pk_bf16_f32 v37, v90, v91
    v_cvt_pk_bf16_f32 v38, v92, v93
    v_cvt_pk_bf16_f32 v39, v94, v95
    s_waitcnt lgkmcnt(7)
    s_nop 0
    v_mfma_f32_32x32x16_bf16 v[20:35], v[216:219], v[36:39], v[20:35]
    ds_read_b128 v[216:219], v9 offset:6144
    v_cvt_pk_bf16_f32 v40, v96, v97
    v_cvt_pk_bf16_f32 v41, v98, v99
    v_cvt_pk_bf16_f32 v42, v100, v101
    v_cvt_pk_bf16_f32 v43, v102, v103
    s_waitcnt lgkmcnt(7)
    s_nop 0
    v_mfma_f32_32x32x16_bf16 v[20:35], v[220:223], v[40:43], v[20:35]
    ds_read_b128 v[220:223], v9 offset:6656
    v_cvt_pk_bf16_f32 v44, v104, v105
    v_cvt_pk_bf16_f32 v45, v106, v107
    v_cvt_pk_bf16_f32 v46, v108, v109
    v_cvt_pk_bf16_f32 v47, v110, v111
    s_waitcnt lgkmcnt(7)
    s_nop 0
    v_mfma_f32_32x32x16_bf16 v[20:35], v[224:227], v[44:47], v[20:35]
    ds_read_b128 v[224:227], v9 offset:7168
    v_cvt_pk_bf16_f32 v48, v112, v113
    v_cvt_pk_bf16_f32 v49, v114, v115
    v_cvt_pk_bf16_f32 v50, v116, v117
    v_cvt_pk_bf16_f32 v51, v118, v119
    s_waitcnt lgkmcnt(7)
    s_nop 0
    v_mfma_f32_32x32x16_bf16 v[20:35], v[228:231], v[48:51], v[20:35]
    ds_read_b128 v[228:231], v9 offset:7680
    v_cvt_pk_bf16_f32 v36, v120, v121
    v_cvt_pk_bf16_f32 v37, v122, v123
    v_cvt_pk_bf16_f32 v38, v124, v125
    v_cvt_pk_bf16_f32 v39, v126, v127
    s_waitcnt lgkmcnt(7)
    s_nop 0
    v_mfma_f32_32x32x16_bf16 v[20:35], v[200:203], v[36:39], v[20:35]
    ds_read_b128 v[200:203], v9 offset:8192
    v_cvt_pk_bf16_f32 v40, v128, v129
    v_cvt_pk_bf16_f32 v41, v130, v131
    v_cvt_pk_bf16_f32 v42, v132, v133
    v_cvt_pk_bf16_f32 v43, v134, v135
    s_waitcnt lgkmcnt(7)
    s_nop 0
    v_mfma_f32_32x32x16_bf16 v[20:35], v[204:207], v[40:43], v[20:35]
    ds_read_b128 v[204:207], v9 offset:8704
    v_cvt_pk_bf16_f32 v44, v136, v137
    v_cvt_pk_bf16_f32 v45, v138, v139
    v_cvt_pk_bf16_f32 v46, v140, v141
    v_cvt_pk_bf16_f32 v47, v142, v143
    s_waitcnt lgkmcnt(7)
    s_nop 0
    v_mfma_f32_32x32x16_bf16 v[20:35], v[208:211], v[44:47], v[20:35]
    v_cvt_pk_bf16_f32 v48, v144, v145
    v_cvt_pk_bf16_f32 v49, v146, v147
    v_cvt_pk_bf16_f32 v50, v148, v149
    v_cvt_pk_bf16_f32 v51, v150, v151
    s_waitcnt lgkmcnt(6)
    s_nop 0
    v_mfma_f32_32x32x16_bf16 v[20:35], v[212:215], v[48:51], v[20:35]
    v_cvt_pk_bf16_f32 v36, v152, v153
    v_cvt_pk_bf16_f32 v37, v154, v155
    v_cvt_pk_bf16_f32 v38, v156, v157
    v_cvt_pk_bf16_f32 v39, v158, v159
    s_waitcnt lgkmcnt(5)
    s_nop 0
    v_mfma_f32_32x32x16_bf16 v[20:35], v[216:219], v[36:39], v[20:35]
    v_cvt_pk_bf16_f32 v40, v160, v161
    v_cvt_pk_bf16_f32 v41, v162, v163
    v_cvt_pk_bf16_f32 v42, v164, v165
    v_cvt_pk_bf16_f32 v43, v166, v167
    s_waitcnt lgkmcnt(4)
    s_nop 0
    v_mfma_f32_32x32x16_bf16 v[20:35], v[220:223], v[40:43], v[20:35]
    v_cvt_pk_bf16_f32 v44, v168, v169
    v_cvt_pk_bf16_f32 v45, v170, v171
    v_cvt_pk_bf16_f32 v46, v172, v173
    v_cvt_pk_bf16_f32 v47, v174, v175
    s_waitcnt lgkmcnt(3)
    s_nop 0
    v_mfma_f32_32x32x16_bf16 v[20:35], v[224:227], v[44:47], v[20:35]
    v_cvt_pk_bf16_f32 v48, v176, v177
    v_cvt_pk_bf16_f32 v49, v178, v179
    v_cvt_pk_bf16_f32 v50, v180, v181
    v_cvt_pk_bf16_f32 v51, v182, v183
    s_waitcnt lgkmcnt(2)
    s_nop 0
    v_mfma_f32_32x32x16_bf16 v[20:35], v[228:231], v[48:51], v[20:35]
    v_cvt_pk_bf16_f32 v36, v184, v185
    v_cvt_pk_bf16_f32 v37, v186, v187
    v_cvt_pk_bf16_f32 v38, v188, v189
    v_cvt_pk_bf16_f32 v39, v190, v191
    s_waitcnt lgkmcnt(1)
    s_nop 0
    v_mfma_f32_32x32x16_bf16 v[20:35], v[200:203], v[36:39], v[20:35]
    v_cvt_pk_bf16_f32 v40, v192, v193
    v_cvt_pk_bf16_f32 v41, v194, v195
    v_cvt_pk_bf16_f32 v42, v196, v197
    v_cvt_pk_bf16_f32 v43, v198, v199
    s_waitcnt lgkmcnt(0)
    s_nop 0
    v_mfma_f32_32x32x16_bf16 v[20:35], v[204:207], v[40:43], v[20:35]
    s_nop 15
    v_rcp_f32 v11, v28
    s_nop 0
    v_mul_f32 v20, v11, v20
    v_mul_f32 v21, v11, v21
    v_mul_f32 v22, v11, v22
    v_mul_f32 v23, v11, v23
    v_mul_f32 v24, v11, v24
    v_mul_f32 v25, v11, v25
    v_mul_f32 v26, v11, v26
    v_mul_f32 v27, v11, v27
    v_cvt_pk_bf16_f32 v36, v20, v21
    v_cvt_pk_bf16_f32 v37, v22, v23
    v_cvt_pk_bf16_f32 v38, v24, v25
    v_cvt_pk_bf16_f32 v39, v26, v27
    s_nop 1
    v_permlane32_swap_b32 v36, v38
    v_permlane32_swap_b32 v37, v39
    s_nop 1
    v_lshlrev_b32 v3, 4, v1
    s_lshl_b32 s28, s29, 5
    s_add_u32 s28, s28, s24
    s_lshl_b32 s28, s28, 10
    buffer_store_dwordx4 v[36:39], v3, s[32:35], s28 offen
    s_waitcnt vmcnt(0)
L_kattn_kernel_end:
    s_endpgm
.globl kwo_kernel
.p2align 8
.type kwo_kernel,@function
kwo_kernel:
    s_cmp_ge_u32 s2, 256
    s_cbranch_scc1 L_kwo_kernel_end
    s_load_dwordx2 s[4:5], s[0:1], 0
    s_load_dwordx2 s[6:7], s[0:1], 16
    s_load_dwordx4 s[8:11], s[0:1], 56
    s_load_dwordx2 s[54:55], s[0:1], 48
    s_and_b32 s24, s2, 7
    s_lshr_b32 s25, s2, 3
    s_and_b32 s26, s25, 3
    s_lshl_b32 s24, s24, 2
    s_add_u32 s24, s24, s26
    s_lshr_b32 s25, s25, 2
    s_lshl_b32 s50, s24, 1
    v_and_b32 v1, 63, v0
    v_lshrrev_b32 v9, 6, v0
    s_nop 0
    v_readfirstlane_b32 s26, v9
    v_lshrrev_b32 v13, 5, v1
    s_and_b32 s48, s26, 3
    s_lshr_b32 s57, s26, 2
    s_cmp_ge_u32 s26, 8
    s_cbranch_scc1 L_kwo_kernel_compute
    v_lshrrev_b32 v9, 3, v1
    v_and_b32 v10, 7, v1
    v_bfe_u32 v11, v1, 4, 1
    v_lshlrev_b32 v11, 2, v11
    v_xor_b32 v10, v10, v11
    v_lshlrev_b32 v3, 10, v9
    s_lshl_b32 s36, s25, 7
    v_lshlrev_b32 v11, 4, v10
    v_add_u32 v11, s36, v11
    v_add_u32 v3, v3, v11
    v_lshlrev_b32 v2, 4, v1
    s_lshr_b32 s52, s48, 1
    s_add_u32 s51, s50, s52
    s_mul_i32 s51, s51, 32768
    s_and_b32 s52, s48, 1
    s_lshl_b32 s52, s52, 12
    s_add_u32 s51, s51, s52
    s_lshl_b32 s53, s48, 12
    s_mul_i32 s43, s48, 32768
    s_waitcnt lgkmcnt(0)
    s_mov_b32 s16, s6
    s_and_b32 s17, s7, 0xffff
    s_mov_b32 s18, 524288
    s_mov_b32 s19, 0x00020000
    s_add_u32 s12, s10, 8388608
    s_addc_u32 s13, s11, 0
    s_and_b32 s13, s13, 0xffff
    s_mov_b32 s14, 2097152
    s_mov_b32 s15, 0x00020000
    s_lshl_b32 s58, s57, 11
    s_add_u32 s53, s53, s58
    s_lshl_b32 s59, s57, 11
    s_add_u32 s51, s51, s59
    s_mul_i32 s59, s57, 16384
    s_add_u32 s43, s43, s59
    s_add_u32 s44, s53, 0
    s_mov_b32 m0, s44
    s_add_u32 s45, s51, 0
    buffer_load_dwordx4 v2, s[12:15], s45 offen lds
    s_add_u32 s44, s53, 1024
    s_mov_b32 m0, s44
    s_add_u32 s45, s51, 1024
    buffer_load_dwordx4 v2, s[12:15], s45 offen lds
    s_add_u32 s44, s53, 16384
    s_mov_b32 m0, s44
    s_add_u32 s45, s43, 0
    buffer_load_dwordx4 v3, s[16:19], s45 offen lds
    s_add_u32 s44, s53, 17408
    s_mov_b32 m0, s44
    s_add_u32 s45, s43, 8192
    buffer_load_dwordx4 v3, s[16:19], s45 offen lds
    s_barrier
    s_add_u32 s44, s53, 32768
    s_mov_b32 m0, s44
    s_add_u32 s45, s51, 8192
    buffer_load_dwordx4 v2, s[12:15], s45 offen lds
    s_add_u32 s44, s53, 33792
    s_mov_b32 m0, s44
    s_add_u32 s45, s51, 9216
    buffer_load_dwordx4 v2, s[12:15], s45 offen lds
    s_add_u32 s44, s53, 49152
    s_mov_b32 m0, s44
    s_add_u32 s45, s43, 131072
    buffer_load_dwordx4 v3, s[16:19], s45 offen lds
    s_add_u32 s44, s53, 50176
    s_mov_b32 m0, s44
    s_add_u32 s45, s43, 139264
    buffer_load_dwordx4 v3, s[16:19], s45 offen lds
    s_barrier
    s_add_u32 s44, s53, 65536
    s_mov_b32 m0, s44
    s_add_u32 s45, s51, 16384
    buffer_load_dwordx4 v2, s[12:15], s45 offen lds
    s_add_u32 s44, s53, 66560
    s_mov_b32 m0, s44
    s_add_u32 s45, s51, 17408
    buffer_load_dwordx4 v2, s[12:15], s45 offen lds
    s_add_u32 s44, s53, 81920
    s_mov_b32 m0, s44
    s_add_u32 s45, s43, 262144
    buffer_load_dwordx4 v3, s[16:19], s45 offen lds
    s_add_u32 s44, s53, 82944
    s_mov_b32 m0, s44
    s_add_u32 s45, s43, 270336
    buffer_load_dwordx4 v3, s[16:19], s45 offen lds
    s_waitcnt vmcnt(8)
    s_barrier
    s_add_u32 s44, s53, 98304
    s_mov_b32 m0, s44
    s_add_u32 s45, s51, 24576
    buffer_load_dwordx4 v2, s[12:15], s45 offen lds
    s_add_u32 s44, s53, 99328
    s_mov_b32 m0, s44
    s_add_u32 s45, s51, 25600
    buffer_load_dwordx4 v2, s[12:15], s45 offen lds
    s_add_u32 s44, s53, 114688
    s_mov_b32 m0, s44
    s_add_u32 s45, s43, 393216
    buffer_load_dwordx4 v3, s[16:19], s45 offen lds
    s_add_u32 s44, s53, 115712
    s_mov_b32 m0, s44
    s_add_u32 s45, s43, 401408
    buffer_load_dwordx4 v3, s[16:19], s45 offen lds
    s_waitcnt vmcnt(8)
    s_barrier
    s_waitcnt vmcnt(4)
    s_barrier
    s_waitcnt vmcnt(0)
    s_barrier
    s_branch L_kwo_kernel_end
L_kwo_kernel_compute:
    s_and_b32 s42, s48, 1
    s_add_u32 s50, s50, s42
    s_lshr_b32 s49, s48, 1
    s_lshl_b32 s27, s50, 5
    v_and_b32 v9, 31, v1
    v_add_u32 v14, s27, v9
    v_lshlrev_b32 v60, 4, v1
    s_mul_i32 s36, s42, 8192
    v_add_u32 v60, s36, v60
    v_lshrrev_b32 v9, 2, v1
    v_and_b32 v9, 3, v9
    v_lshlrev_b32 v10, 3, v13
    v_add_u32 v10, v10, v9
    v_lshlrev_b32 v10, 7, v10
    v_lshrrev_b32 v11, 4, v1
    v_and_b32 v11, 1, v11
    v_lshlrev_b32 v11, 5, v11
    v_and_b32 v12, 3, v1
    v_lshlrev_b32 v12, 3, v12
    v_add_u32 v10, v10, v11
    v_add_u32 v10, v10, v12
    v_lshrrev_b32 v11, 1, v9
    v_xor_b32 v11, s49, v11
    v_lshlrev_b32 v11, 6, v11
    v_add_u32 v40, v10, v11
    v_add_u32 v43, 65536, v40
    v_add_u32 v61, 65536, v60
    s_mov_b32 s40, 0x3f803f80
    s_waitcnt lgkmcnt(0)
    s_mov_b32 s20, s10
    s_and_b32 s21, s11, 0xffff
    s_mov_b32 s22, 33554432
    s_mov_b32 s23, 0x00020000
    s_mov_b32 s28, s4
    s_and_b32 s29, s5, 0xffff
    s_mov_b32 s30, 2097152
    s_mov_b32 s31, 0x00020000
    s_add_u32 s32, s10, 12582912
    s_addc_u32 s33, s11, 0
    s_and_b32 s33, s33, 0xffff
    s_mov_b32 s34, 2097152
    s_mov_b32 s35, 0x00020000
    s_lshl_b32 s37, s25, 1
    s_add_u32 s37, s37, s49
    s_lshl_b32 s36, s50, 15
    s_lshl_b32 s41, s37, 11
    s_add_u32 s36, s36, s41
    v_lshlrev_b32 v47, 4, v1
    v_add_u32 v47, s36, v47
    v_lshlrev_b32 v9, 10, v14
    v_lshlrev_b32 v10, 4, v13
    v_add_u32 v9, v9, v10
    s_lshl_b32 s36, s37, 6
    v_add_u32 v46, s36, v9
    buffer_load_dwordx4 v[112:115], v46, s[28:31], 0 offen
    buffer_load_dwordx4 v[116:119], v46, s[28:31], 0 offen offset:32
    s_barrier
    s_barrier
    s_barrier
    ds_read_b128 v[52:55], v60 offset:0
    ds_read_b64_tr_b16 v[16:17], v40 offset:16384
    ds_read_b64_tr_b16 v[18:19], v40 offset:16896
    ds_read_b128 v[56:59], v60 offset:1024
    ds_read_b64_tr_b16 v[20:21], v40 offset:18432
    ds_read_b64_tr_b16 v[22:23], v40 offset:18944
    s_waitcnt lgkmcnt(3)
    v_mfma_f32_32x32x16_bf16 v[64:79], v[16:19], v[52:55], 0
    ds_read_b128 v[52:55], v60 offset:2048
    ds_read_b64_tr_b16 v[16:17], v40 offset:20480
    ds_read_b64_tr_b16 v[18:19], v40 offset:20992
    s_waitcnt lgkmcnt(3)
    v_mfma_f32_32x32x16_bf16 v[64:79], v[20:23], v[56:59], v[64:79]
    ds_read_b128 v[56:59], v60 offset:3072
    ds_read_b64_tr_b16 v[20:21], v40 offset:22528
    ds_read_b64_tr_b16 v[22:23], v40 offset:23040
    s_waitcnt lgkmcnt(3)
    v_mfma_f32_32x32x16_bf16 v[64:79], v[16:19], v[52:55], v[64:79]
    ds_read_b128 v[52:55], v60 offset:4096
    ds_read_b64_tr_b16 v[16:17], v40 offset:24576
    ds_read_b64_tr_b16 v[18:19], v40 offset:25088
    s_waitcnt lgkmcnt(3)
    v_mfma_f32_32x32x16_bf16 v[64:79], v[20:23], v[56:59], v[64:79]
    ds_read_b128 v[56:59], v60 offset:5120
    ds_read_b64_tr_b16 v[20:21], v40 offset:26624
    ds_read_b64_tr_b16 v[22:23], v40 offset:27136
    s_waitcnt lgkmcnt(3)
    v_mfma_f32_32x32x16_bf16 v[64:79], v[16:19], v[52:55], v[64:79]
    ds_read_b128 v[52:55], v60 offset:6144
    ds_read_b64_tr_b16 v[16:17], v40 offset:28672
    ds_read_b64_tr_b16 v[18:19], v40 offset:29184
    s_waitcnt lgkmcnt(3)
    v_mfma_f32_32x32x16_bf16 v[64:79], v[20:23], v[56:59], v[64:79]
    ds_read_b128 v[56:59], v60 offset:7168
    ds_read_b64_tr_b16 v[20:21], v40 offset:30720
    ds_read_b64_tr_b16 v[22:23], v40 offset:31232
    s_waitcnt lgkmcnt(3)
    v_mfma_f32_32x32x16_bf16 v[64:79], v[16:19], v[52:55], v[64:79]
    s_waitcnt lgkmcnt(0)
    v_mfma_f32_32x32x16_bf16 v[64:79], v[20:23], v[56:59], v[64:79]
    s_barrier
    ds_read_b128 v[52:55], v60 offset:32768
    ds_read_b64_tr_b16 v[16:17], v40 offset:49152
    ds_read_b64_tr_b16 v[18:19], v40 offset:49664
    ds_read_b128 v[56:59], v60 offset:33792
    ds_read_b64_tr_b16 v[20:21], v40 offset:51200
    ds_read_b64_tr_b16 v[22:23], v40 offset:51712
    s_waitcnt lgkmcnt(3)
    v_mfma_f32_32x32x16_bf16 v[64:79], v[16:19], v[52:55], v[64:79]
    ds_read_b128 v[52:55], v60 offset:34816
    ds_read_b64_tr_b16 v[16:17], v40 offset:53248
    ds_read_b64_tr_b16 v[18:19], v40 offset:53760
    s_waitcnt lgkmcnt(3)
    v_mfma_f32_32x32x16_bf16 v[64:79], v[20:23], v[56:59], v[64:79]
    ds_read_b128 v[56:59], v60 offset:35840
    ds_read_b64_tr_b16 v[20:21], v40 offset:55296
    ds_read_b64_tr_b16 v[22:23], v40 offset:55808
    s_waitcnt lgkmcnt(3)
    v_mfma_f32_32x32x16_bf16 v[64:79], v[16:19], v[52:55], v[64:79]
    ds_read_b128 v[52:55], v60 offset:36864
    ds_read_b64_tr_b16 v[16:17], v40 offset:57344
    ds_read_b64_tr_b16 v[18:19], v40 offset:57856
    s_waitcnt lgkmcnt(3)
    v_mfma_f32_32x32x16_bf16 v[64:79], v[20:23], v[56:59], v[64:79]
    ds_read_b128 v[56:59], v60 offset:37888
    ds_read_b64_tr_b16 v[20:21], v40 offset:59392
    ds_read_b64_tr_b16 v[22:23], v40 offset:59904
    s_waitcnt lgkmcnt(3)
    v_mfma_f32_32x32x16_bf16 v[64:79], v[16:19], v[52:55], v[64:79]
    ds_read_b128 v[52:55], v60 offset:38912
    ds_read_b64_tr_b16 v[16:17], v40 offset:61440
    ds_read_b64_tr_b16 v[18:19], v40 offset:61952
    s_waitcnt lgkmcnt(3)
    v_mfma_f32_32x32x16_bf16 v[64:79], v[20:23], v[56:59], v[64:79]
    ds_read_b128 v[56:59], v60 offset:39936
    ds_read_b64_tr_b16 v[20:21], v40 offset:63488
    ds_read_b64_tr_b16 v[22:23], v40 offset:64000
    s_waitcnt lgkmcnt(3)
    v_mfma_f32_32x32x16_bf16 v[64:79], v[16:19], v[52:55], v[64:79]
    s_waitcnt lgkmcnt(0)
    v_mfma_f32_32x32x16_bf16 v[64:79], v[20:23], v[56:59], v[64:79]
    s_barrier
    ds_read_b128 v[52:55], v61 offset:0
    ds_read_b64_tr_b16 v[16:17], v43 offset:16384
    ds_read_b64_tr_b16 v[18:19], v43 offset:16896
    ds_read_b128 v[56:59], v61 offset:1024
    ds_read_b64_tr_b16 v[20:21], v43 offset:18432
    ds_read_b64_tr_b16 v[22:23], v43 offset:18944
    s_waitcnt lgkmcnt(3)
    v_mfma_f32_32x32x16_bf16 v[64:79], v[16:19], v[52:55], v[64:79]
    ds_read_b128 v[52:55], v61 offset:2048
    ds_read_b64_tr_b16 v[16:17], v43 offset:20480
    ds_read_b64_tr_b16 v[18:19], v43 offset:20992
    s_waitcnt lgkmcnt(3)
    v_mfma_f32_32x32x16_bf16 v[64:79], v[20:23], v[56:59], v[64:79]
    ds_read_b128 v[56:59], v61 offset:3072
    ds_read_b64_tr_b16 v[20:21], v43 offset:22528
    ds_read_b64_tr_b16 v[22:23], v43 offset:23040
    s_waitcnt lgkmcnt(3)
    v_mfma_f32_32x32x16_bf16 v[64:79], v[16:19], v[52:55], v[64:79]
    ds_read_b128 v[52:55], v61 offset:4096
    ds_read_b64_tr_b16 v[16:17], v43 offset:24576
    ds_read_b64_tr_b16 v[18:19], v43 offset:25088
    s_waitcnt lgkmcnt(3)
    v_mfma_f32_32x32x16_bf16 v[64:79], v[20:23], v[56:59], v[64:79]
    ds_read_b128 v[56:59], v61 offset:5120
    ds_read_b64_tr_b16 v[20:21], v43 offset:26624
    ds_read_b64_tr_b16 v[22:23], v43 offset:27136
    s_waitcnt lgkmcnt(3)
    v_mfma_f32_32x32x16_bf16 v[64:79], v[16:19], v[52:55], v[64:79]
    ds_read_b128 v[52:55], v61 offset:6144
    ds_read_b64_tr_b16 v[16:17], v43 offset:28672
    ds_read_b64_tr_b16 v[18:19], v43 offset:29184
    s_waitcnt lgkmcnt(3)
    v_mfma_f32_32x32x16_bf16 v[64:79], v[20:23], v[56:59], v[64:79]
    ds_read_b128 v[56:59], v61 offset:7168
    ds_read_b64_tr_b16 v[20:21], v43 offset:30720
    ds_read_b64_tr_b16 v[22:23], v43 offset:31232
    s_waitcnt lgkmcnt(3)
    v_mfma_f32_32x32x16_bf16 v[64:79], v[16:19], v[52:55], v[64:79]
    s_waitcnt lgkmcnt(0)
    v_mfma_f32_32x32x16_bf16 v[64:79], v[20:23], v[56:59], v[64:79]
    s_barrier
    ds_read_b128 v[52:55], v61 offset:32768
    ds_read_b64_tr_b16 v[16:17], v43 offset:49152
    ds_read_b64_tr_b16 v[18:19], v43 offset:49664
    ds_read_b128 v[56:59], v61 offset:33792
    ds_read_b64_tr_b16 v[20:21], v43 offset:51200
    ds_read_b64_tr_b16 v[22:23], v43 offset:51712
    s_waitcnt lgkmcnt(3)
    v_mfma_f32_32x32x16_bf16 v[64:79], v[16:19], v[52:55], v[64:79]
    ds_read_b128 v[52:55], v61 offset:34816
    ds_read_b64_tr_b16 v[16:17], v43 offset:53248
    ds_read_b64_tr_b16 v[18:19], v43 offset:53760
    s_waitcnt lgkmcnt(3)
    v_mfma_f32_32x32x16_bf16 v[64:79], v[20:23], v[56:59], v[64:79]
    ds_read_b128 v[56:59], v61 offset:35840
    ds_read_b64_tr_b16 v[20:21], v43 offset:55296
    ds_read_b64_tr_b16 v[22:23], v43 offset:55808
    s_waitcnt lgkmcnt(3)
    v_mfma_f32_32x32x16_bf16 v[64:79], v[16:19], v[52:55], v[64:79]
    ds_read_b128 v[52:55], v61 offset:36864
    ds_read_b64_tr_b16 v[16:17], v43 offset:57344
    ds_read_b64_tr_b16 v[18:19], v43 offset:57856
    s_waitcnt lgkmcnt(3)
    v_mfma_f32_32x32x16_bf16 v[64:79], v[20:23], v[56:59], v[64:79]
    ds_read_b128 v[56:59], v61 offset:37888
    ds_read_b64_tr_b16 v[20:21], v43 offset:59392
    ds_read_b64_tr_b16 v[22:23], v43 offset:59904
    s_waitcnt lgkmcnt(3)
    v_mfma_f32_32x32x16_bf16 v[64:79], v[16:19], v[52:55], v[64:79]
    ds_read_b128 v[52:55], v61 offset:38912
    ds_read_b64_tr_b16 v[16:17], v43 offset:61440
    ds_read_b64_tr_b16 v[18:19], v43 offset:61952
    s_waitcnt lgkmcnt(3)
    v_mfma_f32_32x32x16_bf16 v[64:79], v[20:23], v[56:59], v[64:79]
    ds_read_b128 v[56:59], v61 offset:39936
    ds_read_b64_tr_b16 v[20:21], v43 offset:63488
    ds_read_b64_tr_b16 v[22:23], v43 offset:64000
    s_waitcnt lgkmcnt(3)
    v_mfma_f32_32x32x16_bf16 v[64:79], v[16:19], v[52:55], v[64:79]
    s_waitcnt lgkmcnt(0)
    v_mfma_f32_32x32x16_bf16 v[64:79], v[20:23], v[56:59], v[64:79]
    s_nop 15
    v_cvt_pk_bf16_f32 v64, v64, v65
    v_cvt_pk_bf16_f32 v65, v66, v67
    v_cvt_pk_bf16_f32 v66, v68, v69
    v_cvt_pk_bf16_f32 v67, v70, v71
    v_cvt_pk_bf16_f32 v68, v72, v73
    v_cvt_pk_bf16_f32 v69, v74, v75
    v_cvt_pk_bf16_f32 v70, v76, v77
    v_cvt_pk_bf16_f32 v71, v78, v79
    s_nop 1
    v_permlane32_swap_b32 v64, v66
    v_permlane32_swap_b32 v65, v67
    v_permlane32_swap_b32 v68, v70
    v_permlane32_swap_b32 v69, v71
    s_nop 1
    s_waitcnt vmcnt(0)
    v_lshlrev_b32 v9, 16, v64
    v_and_b32 v10, 0xffff0000, v64
    v_lshlrev_b32 v11, 16, v112
    v_and_b32 v12, 0xffff0000, v112
    v_add_f32 v9, v9, v11
    v_add_f32 v10, v10, v12
    v_cvt_pk_bf16_f32 v64, v9, v10
    v_lshlrev_b32 v9, 16, v65
    v_and_b32 v10, 0xffff0000, v65
    v_lshlrev_b32 v11, 16, v113
    v_and_b32 v12, 0xffff0000, v113
    v_add_f32 v9, v9, v11
    v_add_f32 v10, v10, v12
    v_cvt_pk_bf16_f32 v65, v9, v10
    v_lshlrev_b32 v9, 16, v66
    v_and_b32 v10, 0xffff0000, v66
    v_lshlrev_b32 v11, 16, v114
    v_and_b32 v12, 0xffff0000, v114
    v_add_f32 v9, v9, v11
    v_add_f32 v10, v10, v12
    v_cvt_pk_bf16_f32 v66, v9, v10
    v_lshlrev_b32 v9, 16, v67
    v_and_b32 v10, 0xffff0000, v67
    v_lshlrev_b32 v11, 16, v115
    v_and_b32 v12, 0xffff0000, v115
    v_add_f32 v9, v9, v11
    v_add_f32 v10, v10, v12
    v_cvt_pk_bf16_f32 v67, v9, v10
    v_lshlrev_b32 v9, 16, v68
    v_and_b32 v10, 0xffff0000, v68
    v_lshlrev_b32 v11, 16, v116
    v_and_b32 v12, 0xffff0000, v116
    v_add_f32 v9, v9, v11
    v_add_f32 v10, v10, v12
    v_cvt_pk_bf16_f32 v68, v9, v10
    v_lshlrev_b32 v9, 16, v69
    v_and_b32 v10, 0xffff0000, v69
    v_lshlrev_b32 v11, 16, v117
    v_and_b32 v12, 0xffff0000, v117
    v_add_f32 v9, v9, v11
    v_add_f32 v10, v10, v12
    v_cvt_pk_bf16_f32 v69, v9, v10
    v_lshlrev_b32 v9, 16, v70
    v_and_b32 v10, 0xffff0000, v70
    v_lshlrev_b32 v11, 16, v118
    v_and_b32 v12, 0xffff0000, v118
    v_add_f32 v9, v9, v11
    v_add_f32 v10, v10, v12
    v_cvt_pk_bf16_f32 v70, v9, v10
    v_lshlrev_b32 v9, 16, v71
    v_and_b32 v10, 0xffff0000, v71
    v_lshlrev_b32 v11, 16, v119
    v_and_b32 v12, 0xffff0000, v119
    v_add_f32 v9, v9, v11
    v_add_f32 v10, v10, v12
    v_cvt_pk_bf16_f32 v71, v9, v10
    buffer_store_dwordx4 v[64:67], v47, s[32:35], 0 offen
    buffer_store_dwordx4 v[68:71], v47, s[32:35], 0 offen offset:1024
    s_waitcnt vmcnt(0)
L_kwo_kernel_end:
    s_endpgm
.globl kw1_kernel
.p2align 8
.type kw1_kernel,@function
kw1_kernel:
    s_cmp_ge_u32 s2, 240
    s_cbranch_scc1 L_kw1_kernel_end
    s_load_dwordx2 s[4:5], s[0:1], 0
    s_load_dwordx2 s[6:7], s[0:1], 32
    s_load_dwordx4 s[8:11], s[0:1], 56
    s_load_dwordx2 s[54:55], s[0:1], 48
    s_and_b32 s24, s2, 7
    s_lshr_b32 s25, s2, 3
    s_and_b32 s26, s25, 1
    s_lshl_b32 s24, s24, 1
    s_add_u32 s24, s24, s26
    s_lshr_b32 s25, s25, 1
    s_lshl_b32 s50, s24, 2
    v_and_b32 v1, 63, v0
    v_lshrrev_b32 v9, 6, v0
    s_nop 0
    v_readfirstlane_b32 s26, v9
    v_lshrrev_b32 v13, 5, v1
    s_and_b32 s48, s26, 3
    s_lshr_b32 s57, s26, 2
    s_cmp_ge_u32 s26, 8
    s_cbranch_scc1 L_kw1_kernel_compute
    v_lshrrev_b32 v9, 4, v1
    v_and_b32 v10, 15, v1
    v_lshlrev_b32 v11, 2, v9
    v_xor_b32 v10, v10, v11
    s_mov_b32 s36, 2752
    v_mul_lo_u32 v3, v9, s36
    s_mul_i32 s36, s25, 192
    v_lshlrev_b32 v11, 4, v10
    v_add_u32 v11, s36, v11
    v_add_u32 v3, v3, v11
    v_cmp_gt_u32 vcc, 12, v10
    s_mov_b64 s[38:39], vcc
    v_lshlrev_b32 v2, 4, v1
    s_add_u32 s51, s50, s48
    s_mul_i32 s51, s51, 32768
    s_lshl_b32 s53, s48, 12
    s_mul_i32 s43, s48, 44032
    s_waitcnt lgkmcnt(0)
    s_mov_b32 s16, s6
    s_and_b32 s17, s7, 0xffff
    s_mov_b32 s18, 1409024
    s_mov_b32 s19, 0x00020000
    s_add_u32 s12, s10, 12582912
    s_addc_u32 s13, s11, 0
    s_and_b32 s13, s13, 0xffff
    s_mov_b32 s14, 2097152
    s_mov_b32 s15, 0x00020000
    s_lshl_b32 s58, s57, 11
    s_add_u32 s53, s53, s58
    s_lshl_b32 s59, s57, 11
    s_add_u32 s51, s51, s59
    s_mul_i32 s59, s57, 22016
    s_add_u32 s43, s43, s59
    v_lshrrev_b32 v9, 2, v1
    v_and_b32 v9, 3, v9
    v_lshlrev_b32 v10, 3, v13
    v_add_u32 v10, v10, v9
    v_lshlrev_b32 v10, 8, v10
    v_lshrrev_b32 v11, 4, v1
    v_and_b32 v11, 1, v11
    v_lshlrev_b32 v11, 5, v11
    v_and_b32 v12, 3, v1
    v_lshlrev_b32 v12, 3, v12
    v_add_u32 v10, v10, v11
    v_add_u32 v10, v10, v12
    s_lshl_b32 s36, s48, 12
    v_add_u32 v10, s36, v10
    v_xor_b32 v11, 0, v9
    v_lshlrev_b32 v11, 6, v11
    v_add_u32 v40, v10, v11
    v_add_u32 v43, 65536, v40
    v_mov_b32 v6, 0
    v_xor_b32 v11, 1, v9
    v_lshlrev_b32 v11, 6, v11
    v_add_u32 v41, v10, v11
    v_add_u32 v44, 65536, v41
    v_mov_b32 v7, 0
    v_xor_b32 v11, 2, v9
    v_lshlrev_b32 v11, 6, v11
    v_add_u32 v42, v10, v11
    v_add_u32 v45, 65536, v42
    v_mov_b32 v8, 0
    s_mov_b32 s40, 0x3f803f80
    s_add_u32 s44, s53, 0
    s_mov_b32 m0, s44
    s_add_u32 s45, s51, 0
    buffer_load_dwordx4 v2, s[12:15], s45 offen lds
    s_add_u32 s44, s53, 1024
    s_mov_b32 m0, s44
    s_add_u32 s45, s51, 1024
    buffer_load_dwordx4 v2, s[12:15], s45 offen lds
    s_mov_b64 exec, s[38:39]
    s_add_u32 s44, s53, 16384
    s_mov_b32 m0, s44
    s_add_u32 s45, s43, 0
    buffer_load_dwordx4 v3, s[16:19], s45 offen lds
    s_add_u32 s44, s53, 17408
    s_mov_b32 m0, s44
    s_add_u32 s45, s43, 11008
    buffer_load_dwordx4 v3, s[16:19], s45 offen lds
    s_mov_b64 exec, -1
    s_barrier
    s_add_u32 s44, s53, 32768
    s_mov_b32 m0, s44
    s_add_u32 s45, s51, 4096
    buffer_load_dwordx4 v2, s[12:15], s45 offen lds
    s_add_u32 s44, s53, 33792
    s_mov_b32 m0, s44
    s_add_u32 s45, s51, 5120
    buffer_load_dwordx4 v2, s[12:15], s45 offen lds
    s_mov_b64 exec, s[38:39]
    s_add_u32 s44, s53, 49152
    s_mov_b32 m0, s44
    s_add_u32 s45, s43, 176128
    buffer_load_dwordx4 v3, s[16:19], s45 offen lds
    s_add_u32 s44, s53, 50176
    s_mov_b32 m0, s44
    s_add_u32 s45, s43, 187136
    buffer_load_dwordx4 v3, s[16:19], s45 offen lds
    s_mov_b64 exec, -1
    s_barrier
    s_add_u32 s44, s53, 65536
    s_mov_b32 m0, s44
    s_add_u32 s45, s51, 8192
    buffer_load_dwordx4 v2, s[12:15], s45 offen lds
    s_add_u32 s44, s53, 66560
    s_mov_b32 m0, s44
    s_add_u32 s45, s51, 9216
    buffer_load_dwordx4 v2, s[12:15], s45 offen lds
    s_mov_b64 exec, s[38:39]
    s_add_u32 s44, s53, 81920
    s_mov_b32 m0, s44
    s_add_u32 s45, s43, 352256
    buffer_load_dwordx4 v3, s[16:19], s45 offen lds
    s_add_u32 s44, s53, 82944
    s_mov_b32 m0, s44
    s_add_u32 s45, s43, 363264
    buffer_load_dwordx4 v3, s[16:19], s45 offen lds
    s_mov_b64 exec, -1
    s_waitcnt vmcnt(8)
    s_barrier
    s_add_u32 s44, s53, 98304
    s_mov_b32 m0, s44
    s_add_u32 s45, s51, 12288
    buffer_load_dwordx4 v2, s[12:15], s45 offen lds
    s_add_u32 s44, s53, 99328
    s_mov_b32 m0, s44
    s_add_u32 s45, s51, 13312
    buffer_load_dwordx4 v2, s[12:15], s45 offen lds
    s_mov_b64 exec, s[38:39]
    s_add_u32 s44, s53, 114688
    s_mov_b32 m0, s44
    s_add_u32 s45, s43, 528384
    buffer_load_dwordx4 v3, s[16:19], s45 offen lds
    s_add_u32 s44, s53, 115712
    s_mov_b32 m0, s44
    s_add_u32 s45, s43, 539392
    buffer_load_dwordx4 v3, s[16:19], s45 offen lds
    s_mov_b64 exec, -1
    s_cmp_lg_u32 s57, 0
    s_cbranch_scc1 L_kw1_kernel_nocs0
    ds_read_b64_tr_b16 v[16:17], v40 offset:16384
    ds_read_b64_tr_b16 v[18:19], v40 offset:17408
    ds_read_b64_tr_b16 v[20:21], v41 offset:16384
    ds_read_b64_tr_b16 v[22:23], v41 offset:17408
    ds_read_b64_tr_b16 v[24:25], v42 offset:16384
    ds_read_b64_tr_b16 v[26:27], v42 offset:17408
    s_waitcnt lgkmcnt(0)
    v_dot2_f32_bf16 v6, v16, s40, v6
    v_dot2_f32_bf16 v6, v17, s40, v6
    v_dot2_f32_bf16 v6, v18, s40, v6
    v_dot2_f32_bf16 v6, v19, s40, v6
    v_dot2_f32_bf16 v7, v20, s40, v7
    v_dot2_f32_bf16 v7, v21, s40, v7
    v_dot2_f32_bf16 v7, v22, s40, v7
    v_dot2_f32_bf16 v7, v23, s40, v7
    v_dot2_f32_bf16 v8, v24, s40, v8
    v_dot2_f32_bf16 v8, v25, s40, v8
    v_dot2_f32_bf16 v8, v26, s40, v8
    v_dot2_f32_bf16 v8, v27, s40, v8
L_kw1_kernel_nocs0:
    s_waitcnt vmcnt(8)
    s_barrier
    s_add_u32 s44, s53, 0
    s_mov_b32 m0, s44
    s_add_u32 s45, s51, 16384
    buffer_load_dwordx4 v2, s[12:15], s45 offen lds
    s_add_u32 s44, s53, 1024
    s_mov_b32 m0, s44
    s_add_u32 s45, s51, 17408
    buffer_load_dwordx4 v2, s[12:15], s45 offen lds
    s_mov_b64 exec, s[38:39]
    s_add_u32 s44, s53, 16384
    s_mov_b32 m0, s44
    s_add_u32 s45, s43, 704512
    buffer_load_dwordx4 v3, s[16:19], s45 offen lds
    s_add_u32 s44, s53, 17408
    s_mov_b32 m0, s44
    s_add_u32 s45, s43, 715520
    buffer_load_dwordx4 v3, s[16:19], s45 offen lds
    s_mov_b64 exec, -1
    s_cmp_lg_u32 s57, 1
    s_cbranch_scc1 L_kw1_kernel_nocs1
    ds_read_b64_tr_b16 v[16:17], v40 offset:49152
    ds_read_b64_tr_b16 v[18:19], v40 offset:50176
    ds_read_b64_tr_b16 v[20:21], v41 offset:49152
    ds_read_b64_tr_b16 v[22:23], v41 offset:50176
    ds_read_b64_tr_b16 v[24:25], v42 offset:49152
    ds_read_b64_tr_b16 v[26:27], v42 offset:50176
    s_waitcnt lgkmcnt(0)
    v_dot2_f32_bf16 v6, v16, s40, v6
    v_dot2_f32_bf16 v6, v17, s40, v6
    v_dot2_f32_bf16 v6, v18, s40, v6
    v_dot2_f32_bf16 v6, v19, s40, v6
    v_dot2_f32_bf16 v7, v20, s40, v7
    v_dot2_f32_bf16 v7, v21, s40, v7
    v_dot2_f32_bf16 v7, v22, s40, v7
    v_dot2_f32_bf16 v7, v23, s40, v7
    v_dot2_f32_bf16 v8, v24, s40, v8
    v_dot2_f32_bf16 v8, v25, s40, v8
    v_dot2_f32_bf16 v8, v26, s40, v8
    v_dot2_f32_bf16 v8, v27, s40, v8
L_kw1_kernel_nocs1:
    s_waitcnt vmcnt(8)
    s_barrier
    s_add_u32 s44, s53, 32768
    s_mov_b32 m0, s44
    s_add_u32 s45, s51, 20480
    buffer_load_dwordx4 v2, s[12:15], s45 offen lds
    s_add_u32 s44, s53, 33792
    s_mov_b32 m0, s44
    s_add_u32 s45, s51, 21504
    buffer_load_dwordx4 v2, s[12:15], s45 offen lds
    s_mov_b64 exec, s[38:39]
    s_add_u32 s44, s53, 49152
    s_mov_b32 m0, s44
    s_add_u32 s45, s43, 880640
    buffer_load_dwordx4 v3, s[16:19], s45 offen lds
    s_add_u32 s44, s53, 50176
    s_mov_b32 m0, s44
    s_add_u32 s45, s43, 891648
    buffer_load_dwordx4 v3, s[16:19], s45 offen lds
    s_mov_b64 exec, -1
    s_cmp_lg_u32 s57, 0
    s_cbranch_scc1 L_kw1_kernel_nocs2
    ds_read_b64_tr_b16 v[16:17], v43 offset:16384
    ds_read_b64_tr_b16 v[18:19], v43 offset:17408
    ds_read_b64_tr_b16 v[20:21], v44 offset:16384
    ds_read_b64_tr_b16 v[22:23], v44 offset:17408
    ds_read_b64_tr_b16 v[24:25], v45 offset:16384
    ds_read_b64_tr_b16 v[26:27], v45 offset:17408
    s_waitcnt lgkmcnt(0)
    v_dot2_f32_bf16 v6, v16, s40, v6
    v_dot2_f32_bf16 v6, v17, s40, v6
    v_dot2_f32_bf16 v6, v18, s40, v6
    v_dot2_f32_bf16 v6, v19, s40, v6
    v_dot2_f32_bf16 v7, v20, s40, v7
    v_dot2_f32_bf16 v7, v21, s40, v7
    v_dot2_f32_bf16 v7, v22, s40, v7
    v_dot2_f32_bf16 v7, v23, s40, v7
    v_dot2_f32_bf16 v8, v24, s40, v8
    v_dot2_f32_bf16 v8, v25, s40, v8
    v_dot2_f32_bf16 v8, v26, s40, v8
    v_dot2_f32_bf16 v8, v27, s40, v8
L_kw1_kernel_nocs2:
    s_waitcnt vmcnt(8)
    s_barrier
    s_add_u32 s44, s53, 65536
    s_mov_b32 m0, s44
    s_add_u32 s45, s51, 24576
    buffer_load_dwordx4 v2, s[12:15], s45 offen lds
    s_add_u32 s44, s53, 66560
    s_mov_b32 m0, s44
    s_add_u32 s45, s51, 25600
    buffer_load_dwordx4 v2, s[12:15], s45 offen lds
    s_mov_b64 exec, s[38:39]
    s_add_u32 s44, s53, 81920
    s_mov_b32 m0, s44
    s_add_u32 s45, s43, 1056768
    buffer_load_dwordx4 v3, s[16:19], s45 offen lds
    s_add_u32 s44, s53, 82944
    s_mov_b32 m0, s44
    s_add_u32 s45, s43, 1067776
    buffer_load_dwordx4 v3, s[16:19], s45 offen lds
    s_mov_b64 exec, -1
    s_cmp_lg_u32 s57, 1
    s_cbranch_scc1 L_kw1_kernel_nocs3
    ds_read_b64_tr_b16 v[16:17], v43 offset:49152
    ds_read_b64_tr_b16 v[18:19], v43 offset:50176
    ds_read_b64_tr_b16 v[20:21], v44 offset:49152
    ds_read_b64_tr_b16 v[22:23], v44 offset:50176
    ds_read_b64_tr_b16 v[24:25], v45 offset:49152
    ds_read_b64_tr_b16 v[26:27], v45 offset:50176
    s_waitcnt lgkmcnt(0)
    v_dot2_f32_bf16 v6, v16, s40, v6
    v_dot2_f32_bf16 v6, v17, s40, v6
    v_dot2_f32_bf16 v6, v18, s40, v6
    v_dot2_f32_bf16 v6, v19, s40, v6
    v_dot2_f32_bf16 v7, v20, s40, v7
    v_dot2_f32_bf16 v7, v21, s40, v7
    v_dot2_f32_bf16 v7, v22, s40, v7
    v_dot2_f32_bf16 v7, v23, s40, v7
    v_dot2_f32_bf16 v8, v24, s40, v8
    v_dot2_f32_bf16 v8, v25, s40, v8
    v_dot2_f32_bf16 v8, v26, s40, v8
    v_dot2_f32_bf16 v8, v27, s40, v8
L_kw1_kernel_nocs3:
    s_waitcnt vmcnt(8)
    s_barrier
    s_add_u32 s44, s53, 98304
    s_mov_b32 m0, s44
    s_add_u32 s45, s51, 28672
    buffer_load_dwordx4 v2, s[12:15], s45 offen lds
    s_add_u32 s44, s53, 99328
    s_mov_b32 m0, s44
    s_add_u32 s45, s51, 29696
    buffer_load_dwordx4 v2, s[12:15], s45 offen lds
    s_mov_b64 exec, s[38:39]
    s_add_u32 s44, s53, 114688
    s_mov_b32 m0, s44
    s_add_u32 s45, s43, 1232896
    buffer_load_dwordx4 v3, s[16:19], s45 offen lds
    s_add_u32 s44, s53, 115712
    s_mov_b32 m0, s44
    s_add_u32 s45, s43, 1243904
    buffer_load_dwordx4 v3, s[16:19], s45 offen lds
    s_mov_b64 exec, -1
    s_cmp_lg_u32 s57, 0
    s_cbranch_scc1 L_kw1_kernel_nocs4
    ds_read_b64_tr_b16 v[16:17], v40 offset:16384
    ds_read_b64_tr_b16 v[18:19], v40 offset:17408
    ds_read_b64_tr_b16 v[20:21], v41 offset:16384
    ds_read_b64_tr_b16 v[22:23], v41 offset:17408
    ds_read_b64_tr_b16 v[24:25], v42 offset:16384
    ds_read_b64_tr_b16 v[26:27], v42 offset:17408
    s_waitcnt lgkmcnt(0)
    v_dot2_f32_bf16 v6, v16, s40, v6
    v_dot2_f32_bf16 v6, v17, s40, v6
    v_dot2_f32_bf16 v6, v18, s40, v6
    v_dot2_f32_bf16 v6, v19, s40, v6
    v_dot2_f32_bf16 v7, v20, s40, v7
    v_dot2_f32_bf16 v7, v21, s40, v7
    v_dot2_f32_bf16 v7, v22, s40, v7
    v_dot2_f32_bf16 v7, v23, s40, v7
    v_dot2_f32_bf16 v8, v24, s40, v8
    v_dot2_f32_bf16 v8, v25, s40, v8
    v_dot2_f32_bf16 v8, v26, s40, v8
    v_dot2_f32_bf16 v8, v27, s40, v8
L_kw1_kernel_nocs4:
    s_waitcnt vmcnt(8)
    s_barrier
    s_cmp_lg_u32 s57, 1
    s_cbranch_scc1 L_kw1_kernel_nocs5
    ds_read_b64_tr_b16 v[16:17], v40 offset:49152
    ds_read_b64_tr_b16 v[18:19], v40 offset:50176
    ds_read_b64_tr_b16 v[20:21], v41 offset:49152
    ds_read_b64_tr_b16 v[22:23], v41 offset:50176
    ds_read_b64_tr_b16 v[24:25], v42 offset:49152
    ds_read_b64_tr_b16 v[26:27], v42 offset:50176
    s_waitcnt lgkmcnt(0)
    v_dot2_f32_bf16 v6, v16, s40, v6
    v_dot2_f32_bf16 v6, v17, s40, v6
    v_dot2_f32_bf16 v6, v18, s40, v6
    v_dot2_f32_bf16 v6, v19, s40, v6
    v_dot2_f32_bf16 v7, v20, s40, v7
    v_dot2_f32_bf16 v7, v21, s40, v7
    v_dot2_f32_bf16 v7, v22, s40, v7
    v_dot2_f32_bf16 v7, v23, s40, v7
    v_dot2_f32_bf16 v8, v24, s40, v8
    v_dot2_f32_bf16 v8, v25, s40, v8
    v_dot2_f32_bf16 v8, v26, s40, v8
    v_dot2_f32_bf16 v8, v27, s40, v8
L_kw1_kernel_nocs5:
    s_waitcnt vmcnt(4)
    s_barrier
    s_cmp_lg_u32 s57, 0
    s_cbranch_scc1 L_kw1_kernel_nocs6
    ds_read_b64_tr_b16 v[16:17], v43 offset:16384
    ds_read_b64_tr_b16 v[18:19], v43 offset:17408
    ds_read_b64_tr_b16 v[20:21], v44 offset:16384
    ds_read_b64_tr_b16 v[22:23], v44 offset:17408
    ds_read_b64_tr_b16 v[24:25], v45 offset:16384
    ds_read_b64_tr_b16 v[26:27], v45 offset:17408
    s_waitcnt lgkmcnt(0)
    v_dot2_f32_bf16 v6, v16, s40, v6
    v_dot2_f32_bf16 v6, v17, s40, v6
    v_dot2_f32_bf16 v6, v18, s40, v6
    v_dot2_f32_bf16 v6, v19, s40, v6
    v_dot2_f32_bf16 v7, v20, s40, v7
    v_dot2_f32_bf16 v7, v21, s40, v7
    v_dot2_f32_bf16 v7, v22, s40, v7
    v_dot2_f32_bf16 v7, v23, s40, v7
    v_dot2_f32_bf16 v8, v24, s40, v8
    v_dot2_f32_bf16 v8, v25, s40, v8
    v_dot2_f32_bf16 v8, v26, s40, v8
    v_dot2_f32_bf16 v8, v27, s40, v8
L_kw1_kernel_nocs6:
    s_waitcnt vmcnt(0)
    s_barrier
    s_cmp_lg_u32 s57, 1
    s_cbranch_scc1 L_kw1_kernel_nocs7
    ds_read_b64_tr_b16 v[16:17], v43 offset:49152
    ds_read_b64_tr_b16 v[18:19], v43 offset:50176
    ds_read_b64_tr_b16 v[20:21], v44 offset:49152
    ds_read_b64_tr_b16 v[22:23], v44 offset:50176
    ds_read_b64_tr_b16 v[24:25], v45 offset:49152
    ds_read_b64_tr_b16 v[26:27], v45 offset:50176
    s_waitcnt lgkmcnt(0)
    v_dot2_f32_bf16 v6, v16, s40, v6
    v_dot2_f32_bf16 v6, v17, s40, v6
    v_dot2_f32_bf16 v6, v18, s40, v6
    v_dot2_f32_bf16 v6, v19, s40, v6
    v_dot2_f32_bf16 v7, v20, s40, v7
    v_dot2_f32_bf16 v7, v21, s40, v7
    v_dot2_f32_bf16 v7, v22, s40, v7
    v_dot2_f32_bf16 v7, v23, s40, v7
    v_dot2_f32_bf16 v8, v24, s40, v8
    v_dot2_f32_bf16 v8, v25, s40, v8
    v_dot2_f32_bf16 v8, v26, s40, v8
    v_dot2_f32_bf16 v8, v27, s40, v8
L_kw1_kernel_nocs7:
    s_nop 2
    v_mov_b32 v9, v6
    s_nop 1
    v_permlane32_swap_b32 v6, v9
    s_nop 1
    v_add_f32 v6, v6, v9
    v_mov_b32 v9, v7
    s_nop 1
    v_permlane32_swap_b32 v7, v9
    s_nop 1
    v_add_f32 v7, v7, v9
    v_mov_b32 v9, v8
    s_nop 1
    v_permlane32_swap_b32 v8, v9
    s_nop 1
    v_add_f32 v8, v8, v9
    v_and_b32 v9, 31, v1
    v_lshlrev_b32 v9, 2, v9
    s_mul_i32 s36, s26, 384
    s_add_u32 s36, s36, 133120
    v_add_u32 v10, s36, v9
    ds_write_b32 v10, v6 offset:0
    ds_write_b32 v10, v7 offset:128
    ds_write_b32 v10, v8 offset:256
    s_waitcnt lgkmcnt(0)
    s_barrier
    s_branch L_kw1_kernel_end
L_kw1_kernel_compute:
    s_add_u32 s50, s50, s48
    s_mov_b32 s49, 0
    s_mov_b32 s42, s48
    s_lshl_b32 s27, s50, 5
    v_and_b32 v9, 31, v1
    v_add_u32 v14, s27, v9
    v_lshlrev_b32 v60, 4, v1
    s_mul_i32 s36, s42, 4096
    v_add_u32 v60, s36, v60
    v_lshrrev_b32 v9, 2, v1
    v_and_b32 v9, 3, v9
    v_lshlrev_b32 v10, 3, v13
    v_add_u32 v10, v10, v9
    v_lshlrev_b32 v10, 8, v10
    v_lshrrev_b32 v11, 4, v1
    v_and_b32 v11, 1, v11
    v_lshlrev_b32 v11, 5, v11
    v_and_b32 v12, 3, v1
    v_lshlrev_b32 v12, 3, v12
    v_add_u32 v10, v10, v11
    v_add_u32 v10, v10, v12
    v_xor_b32 v11, 0, v9
    v_lshlrev_b32 v11, 6, v11
    v_add_u32 v40, v10, v11
    v_add_u32 v43, 65536, v40
    v_xor_b32 v11, 1, v9
    v_lshlrev_b32 v11, 6, v11
    v_add_u32 v41, v10, v11
    v_add_u32 v44, 65536, v41
    v_xor_b32 v11, 2, v9
    v_lshlrev_b32 v11, 6, v11
    v_add_u32 v42, v10, v11
    v_add_u32 v45, 65536, v42
    v_add_u32 v61, 65536, v60
    s_mov_b32 s40, 0x3f803f80
    v_mov_b32 v4, 0
    v_mov_b32 v5, 0
    s_waitcnt lgkmcnt(0)
    s_mov_b32 s20, s10
    s_and_b32 s21, s11, 0xffff
    s_mov_b32 s22, 33554432
    s_mov_b32 s23, 0x00020000
    s_add_u32 s32, s10, 16777216
    s_addc_u32 s33, s11, 0
    s_and_b32 s33, s33, 0xffff
    s_mov_b32 s34, 5636096
    s_mov_b32 s35, 0x00020000
    s_barrier
    s_barrier
    s_barrier
    ds_read_b128 v[52:55], v60 offset:0
    ds_read_b64_tr_b16 v[16:17], v40 offset:16384
    ds_read_b64_tr_b16 v[18:19], v40 offset:17408
    ds_read_b64_tr_b16 v[20:21], v41 offset:16384
    ds_read_b64_tr_b16 v[22:23], v41 offset:17408
    ds_read_b64_tr_b16 v[24:25], v42 offset:16384
    ds_read_b64_tr_b16 v[26:27], v42 offset:17408
    ds_read_b128 v[56:59], v60 offset:1024
    ds_read_b64_tr_b16 v[28:29], v40 offset:20480
    ds_read_b64_tr_b16 v[30:31], v40 offset:21504
    ds_read_b64_tr_b16 v[32:33], v41 offset:20480
    ds_read_b64_tr_b16 v[34:35], v41 offset:21504
    ds_read_b64_tr_b16 v[36:37], v42 offset:20480
    ds_read_b64_tr_b16 v[38:39], v42 offset:21504
    s_waitcnt lgkmcnt(7)
    v_mfma_f32_32x32x16_bf16 v[64:79], v[16:19], v[52:55], 0
    v_dot2_f32_bf16 v4, v52, s40, v4
    v_dot2_f32_bf16 v4, v53, s40, v4
    v_dot2_f32_bf16 v4, v54, s40, v4
    v_dot2_f32_bf16 v4, v55, s40, v4
    v_mfma_f32_32x32x16_bf16 v[80:95], v[20:23], v[52:55], 0
    v_dot2_f32_bf16 v5, v52, v52, v5
    v_dot2_f32_bf16 v5, v53, v53, v5
    v_dot2_f32_bf16 v5, v54, v54, v5
    v_dot2_f32_bf16 v5, v55, v55, v5
    v_mfma_f32_32x32x16_bf16 v[96:111], v[24:27], v[52:55], 0
    ds_read_b128 v[52:55], v60 offset:2048
    ds_read_b64_tr_b16 v[16:17], v40 offset:24576
    ds_read_b64_tr_b16 v[18:19], v40 offset:25600
    ds_read_b64_tr_b16 v[20:21], v41 offset:24576
    ds_read_b64_tr_b16 v[22:23], v41 offset:25600
    ds_read_b64_tr_b16 v[24:25], v42 offset:24576
    ds_read_b64_tr_b16 v[26:27], v42 offset:25600
    s_waitcnt lgkmcnt(7)
    v_mfma_f32_32x32x16_bf16 v[64:79], v[28:31], v[56:59], v[64:79]
    v_dot2_f32_bf16 v4, v56, s40, v4
    v_dot2_f32_bf16 v4, v57, s40, v4
    v_dot2_f32_bf16 v4, v58, s40, v4
    v_dot2_f32_bf16 v4, v59, s40, v4
    v_mfma_f32_32x32x16_bf16 v[80:95], v[32:35], v[56:59], v[80:95]
    v_dot2_f32_bf16 v5, v56, v56, v5
    v_dot2_f32_bf16 v5, v57, v57, v5
    v_dot2_f32_bf16 v5, v58, v58, v5
    v_dot2_f32_bf16 v5, v59, v59, v5
    v_mfma_f32_32x32x16_bf16 v[96:111], v[36:39], v[56:59], v[96:111]
    ds_read_b128 v[56:59], v60 offset:3072
    ds_read_b64_tr_b16 v[28:29], v40 offset:28672
    ds_read_b64_tr_b16 v[30:31], v40 offset:29696
    ds_read_b64_tr_b16 v[32:33], v41 offset:28672
    ds_read_b64_tr_b16 v[34:35], v41 offset:29696
    ds_read_b64_tr_b16 v[36:37], v42 offset:28672
    ds_read_b64_tr_b16 v[38:39], v42 offset:29696
    s_waitcnt lgkmcnt(7)
    v_mfma_f32_32x32x16_bf16 v[64:79], v[16:19], v[52:55], v[64:79]
    v_dot2_f32_bf16 v4, v52, s40, v4
    v_dot2_f32_bf16 v4, v53, s40, v4
    v_dot2_f32_bf16 v4, v54, s40, v4
    v_dot2_f32_bf16 v4, v55, s40, v4
    v_mfma_f32_32x32x16_bf16 v[80:95], v[20:23], v[52:55], v[80:95]
    v_dot2_f32_bf16 v5, v52, v52, v5
    v_dot2_f32_bf16 v5, v53, v53, v5
    v_dot2_f32_bf16 v5, v54, v54, v5
    v_dot2_f32_bf16 v5, v55, v55, v5
    v_mfma_f32_32x32x16_bf16 v[96:111], v[24:27], v[52:55], v[96:111]
    s_waitcnt lgkmcnt(0)
    v_mfma_f32_32x32x16_bf16 v[64:79], v[28:31], v[56:59], v[64:79]
    v_dot2_f32_bf16 v4, v56, s40, v4
    v_dot2_f32_bf16 v4, v57, s40, v4
    v_dot2_f32_bf16 v4, v58, s40, v4
    v_dot2_f32_bf16 v4, v59, s40, v4
    v_mfma_f32_32x32x16_bf16 v[80:95], v[32:35], v[56:59], v[80:95]
    v_dot2_f32_bf16 v5, v56, v56, v5
    v_dot2_f32_bf16 v5, v57, v57, v5
    v_dot2_f32_bf16 v5, v58, v58, v5
    v_dot2_f32_bf16 v5, v59, v59, v5
    v_mfma_f32_32x32x16_bf16 v[96:111], v[36:39], v[56:59], v[96:111]
    s_barrier
    ds_read_b128 v[52:55], v60 offset:32768
    ds_read_b64_tr_b16 v[16:17], v40 offset:49152
    ds_read_b64_tr_b16 v[18:19], v40 offset:50176
    ds_read_b64_tr_b16 v[20:21], v41 offset:49152
    ds_read_b64_tr_b16 v[22:23], v41 offset:50176
    ds_read_b64_tr_b16 v[24:25], v42 offset:49152
    ds_read_b64_tr_b16 v[26:27], v42 offset:50176
    ds_read_b128 v[56:59], v60 offset:33792
    ds_read_b64_tr_b16 v[28:29], v40 offset:53248
    ds_read_b64_tr_b16 v[30:31], v40 offset:54272
    ds_read_b64_tr_b16 v[32:33], v41 offset:53248
    ds_read_b64_tr_b16 v[34:35], v41 offset:54272
    ds_read_b64_tr_b16 v[36:37], v42 offset:53248
    ds_read_b64_tr_b16 v[38:39], v42 offset:54272
    s_waitcnt lgkmcnt(7)
    v_mfma_f32_32x32x16_bf16 v[64:79], v[16:19], v[52:55], v[64:79]
    v_dot2_f32_bf16 v4, v52, s40, v4
    v_dot2_f32_bf16 v4, v53, s40, v4
    v_dot2_f32_bf16 v4, v54, s40, v4
    v_dot2_f32_bf16 v4, v55, s40, v4
    v_mfma_f32_32x32x16_bf16 v[80:95], v[20:23], v[52:55], v[80:95]
    v_dot2_f32_bf16 v5, v52, v52, v5
    v_dot2_f32_bf16 v5, v53, v53, v5
    v_dot2_f32_bf16 v5, v54, v54, v5
    v_dot2_f32_bf16 v5, v55, v55, v5
    v_mfma_f32_32x32x16_bf16 v[96:111], v[24:27], v[52:55], v[96:111]
    ds_read_b128 v[52:55], v60 offset:34816
    ds_read_b64_tr_b16 v[16:17], v40 offset:57344
    ds_read_b64_tr_b16 v[18:19], v40 offset:58368
    ds_read_b64_tr_b16 v[20:21], v41 offset:57344
    ds_read_b64_tr_b16 v[22:23], v41 offset:58368
    ds_read_b64_tr_b16 v[24:25], v42 offset:57344
    ds_read_b64_tr_b16 v[26:27], v42 offset:58368
    s_waitcnt lgkmcnt(7)
    v_mfma_f32_32x32x16_bf16 v[64:79], v[28:31], v[56:59], v[64:79]
    v_dot2_f32_bf16 v4, v56, s40, v4
    v_dot2_f32_bf16 v4, v57, s40, v4
    v_dot2_f32_bf16 v4, v58, s40, v4
    v_dot2_f32_bf16 v4, v59, s40, v4
    v_mfma_f32_32x32x16_bf16 v[80:95], v[32:35], v[56:59], v[80:95]
    v_dot2_f32_bf16 v5, v56, v56, v5
    v_dot2_f32_bf16 v5, v57, v57, v5
    v_dot2_f32_bf16 v5, v58, v58, v5
    v_dot2_f32_bf16 v5, v59, v59, v5
    v_mfma_f32_32x32x16_bf16 v[96:111], v[36:39], v[56:59], v[96:111]
    ds_read_b128 v[56:59], v60 offset:35840
    ds_read_b64_tr_b16 v[28:29], v40 offset:61440
    ds_read_b64_tr_b16 v[30:31], v40 offset:62464
    ds_read_b64_tr_b16 v[32:33], v41 offset:61440
    ds_read_b64_tr_b16 v[34:35], v41 offset:62464
    ds_read_b64_tr_b16 v[36:37], v42 offset:61440
    ds_read_b64_tr_b16 v[38:39], v42 offset:62464
    s_waitcnt lgkmcnt(7)
    v_mfma_f32_32x32x16_bf16 v[64:79], v[16:19], v[52:55], v[64:79]
    v_dot2_f32_bf16 v4, v52, s40, v4
    v_dot2_f32_bf16 v4, v53, s40, v4
    v_dot2_f32_bf16 v4, v54, s40, v4
    v_dot2_f32_bf16 v4, v55, s40, v4
    v_mfma_f32_32x32x16_bf16 v[80:95], v[20:23], v[52:55], v[80:95]
    v_dot2_f32_bf16 v5, v52, v52, v5
    v_dot2_f32_bf16 v5, v53, v53, v5
    v_dot2_f32_bf16 v5, v54, v54, v5
    v_dot2_f32_bf16 v5, v55, v55, v5
    v_mfma_f32_32x32x16_bf16 v[96:111], v[24:27], v[52:55], v[96:111]
    s_waitcnt lgkmcnt(0)
    v_mfma_f32_32x32x16_bf16 v[64:79], v[28:31], v[56:59], v[64:79]
    v_dot2_f32_bf16 v4, v56, s40, v4
    v_dot2_f32_bf16 v4, v57, s40, v4
    v_dot2_f32_bf16 v4, v58, s40, v4
    v_dot2_f32_bf16 v4, v59, s40, v4
    v_mfma_f32_32x32x16_bf16 v[80:95], v[32:35], v[56:59], v[80:95]
    v_dot2_f32_bf16 v5, v56, v56, v5
    v_dot2_f32_bf16 v5, v57, v57, v5
    v_dot2_f32_bf16 v5, v58, v58, v5
    v_dot2_f32_bf16 v5, v59, v59, v5
    v_mfma_f32_32x32x16_bf16 v[96:111], v[36:39], v[56:59], v[96:111]
    s_barrier
    ds_read_b128 v[52:55], v61 offset:0
    ds_read_b64_tr_b16 v[16:17], v43 offset:16384
    ds_read_b64_tr_b16 v[18:19], v43 offset:17408
    ds_read_b64_tr_b16 v[20:21], v44 offset:16384
    ds_read_b64_tr_b16 v[22:23], v44 offset:17408
    ds_read_b64_tr_b16 v[24:25], v45 offset:16384
    ds_read_b64_tr_b16 v[26:27], v45 offset:17408
    ds_read_b128 v[56:59], v61 offset:1024
    ds_read_b64_tr_b16 v[28:29], v43 offset:20480
    ds_read_b64_tr_b16 v[30:31], v43 offset:21504
    ds_read_b64_tr_b16 v[32:33], v44 offset:20480
    ds_read_b64_tr_b16 v[34:35], v44 offset:21504
    ds_read_b64_tr_b16 v[36:37], v45 offset:20480
    ds_read_b64_tr_b16 v[38:39], v45 offset:21504
    s_waitcnt lgkmcnt(7)
    v_mfma_f32_32x32x16_bf16 v[64:79], v[16:19], v[52:55], v[64:79]
    v_dot2_f32_bf16 v4, v52, s40, v4
    v_dot2_f32_bf16 v4, v53, s40, v4
    v_dot2_f32_bf16 v4, v54, s40, v4
    v_dot2_f32_bf16 v4, v55, s40, v4
    v_mfma_f32_32x32x16_bf16 v[80:95], v[20:23], v[52:55], v[80:95]
    v_dot2_f32_bf16 v5, v52, v52, v5
    v_dot2_f32_bf16 v5, v53, v53, v5
    v_dot2_f32_bf16 v5, v54, v54, v5
    v_dot2_f32_bf16 v5, v55, v55, v5
    v_mfma_f32_32x32x16_bf16 v[96:111], v[24:27], v[52:55], v[96:111]
    ds_read_b128 v[52:55], v61 offset:2048
    ds_read_b64_tr_b16 v[16:17], v43 offset:24576
    ds_read_b64_tr_b16 v[18:19], v43 offset:25600
    ds_read_b64_tr_b16 v[20:21], v44 offset:24576
    ds_read_b64_tr_b16 v[22:23], v44 offset:25600
    ds_read_b64_tr_b16 v[24:25], v45 offset:24576
    ds_read_b64_tr_b16 v[26:27], v45 offset:25600
    s_waitcnt lgkmcnt(7)
    v_mfma_f32_32x32x16_bf16 v[64:79], v[28:31], v[56:59], v[64:79]
    v_dot2_f32_bf16 v4, v56, s40, v4
    v_dot2_f32_bf16 v4, v57, s40, v4
    v_dot2_f32_bf16 v4, v58, s40, v4
    v_dot2_f32_bf16 v4, v59, s40, v4
    v_mfma_f32_32x32x16_bf16 v[80:95], v[32:35], v[56:59], v[80:95]
    v_dot2_f32_bf16 v5, v56, v56, v5
    v_dot2_f32_bf16 v5, v57, v57, v5
    v_dot2_f32_bf16 v5, v58, v58, v5
    v_dot2_f32_bf16 v5, v59, v59, v5
    v_mfma_f32_32x32x16_bf16 v[96:111], v[36:39], v[56:59], v[96:111]
    ds_read_b128 v[56:59], v61 offset:3072
    ds_read_b64_tr_b16 v[28:29], v43 offset:28672
    ds_read_b64_tr_b16 v[30:31], v43 offset:29696
    ds_read_b64_tr_b16 v[32:33], v44 offset:28672
    ds_read_b64_tr_b16 v[34:35], v44 offset:29696
    ds_read_b64_tr_b16 v[36:37], v45 offset:28672
    ds_read_b64_tr_b16 v[38:39], v45 offset:29696
    s_waitcnt lgkmcnt(7)
    v_mfma_f32_32x32x16_bf16 v[64:79], v[16:19], v[52:55], v[64:79]
    v_dot2_f32_bf16 v4, v52, s40, v4
    v_dot2_f32_bf16 v4, v53, s40, v4
    v_dot2_f32_bf16 v4, v54, s40, v4
    v_dot2_f32_bf16 v4, v55, s40, v4
    v_mfma_f32_32x32x16_bf16 v[80:95], v[20:23], v[52:55], v[80:95]
    v_dot2_f32_bf16 v5, v52, v52, v5
    v_dot2_f32_bf16 v5, v53, v53, v5
    v_dot2_f32_bf16 v5, v54, v54, v5
    v_dot2_f32_bf16 v5, v55, v55, v5
    v_mfma_f32_32x32x16_bf16 v[96:111], v[24:27], v[52:55], v[96:111]
    s_waitcnt lgkmcnt(0)
    v_mfma_f32_32x32x16_bf16 v[64:79], v[28:31], v[56:59], v[64:79]
    v_dot2_f32_bf16 v4, v56, s40, v4
    v_dot2_f32_bf16 v4, v57, s40, v4
    v_dot2_f32_bf16 v4, v58, s40, v4
    v_dot2_f32_bf16 v4, v59, s40, v4
    v_mfma_f32_32x32x16_bf16 v[80:95], v[32:35], v[56:59], v[80:95]
    v_dot2_f32_bf16 v5, v56, v56, v5
    v_dot2_f32_bf16 v5, v57, v57, v5
    v_dot2_f32_bf16 v5, v58, v58, v5
    v_dot2_f32_bf16 v5, v59, v59, v5
    v_mfma_f32_32x32x16_bf16 v[96:111], v[36:39], v[56:59], v[96:111]
    s_barrier
    ds_read_b128 v[52:55], v61 offset:32768
    ds_read_b64_tr_b16 v[16:17], v43 offset:49152
    ds_read_b64_tr_b16 v[18:19], v43 offset:50176
    ds_read_b64_tr_b16 v[20:21], v44 offset:49152
    ds_read_b64_tr_b16 v[22:23], v44 offset:50176
    ds_read_b64_tr_b16 v[24:25], v45 offset:49152
    ds_read_b64_tr_b16 v[26:27], v45 offset:50176
    ds_read_b128 v[56:59], v61 offset:33792
    ds_read_b64_tr_b16 v[28:29], v43 offset:53248
    ds_read_b64_tr_b16 v[30:31], v43 offset:54272
    ds_read_b64_tr_b16 v[32:33], v44 offset:53248
    ds_read_b64_tr_b16 v[34:35], v44 offset:54272
    ds_read_b64_tr_b16 v[36:37], v45 offset:53248
    ds_read_b64_tr_b16 v[38:39], v45 offset:54272
    s_waitcnt lgkmcnt(7)
    v_mfma_f32_32x32x16_bf16 v[64:79], v[16:19], v[52:55], v[64:79]
    v_dot2_f32_bf16 v4, v52, s40, v4
    v_dot2_f32_bf16 v4, v53, s40, v4
    v_dot2_f32_bf16 v4, v54, s40, v4
    v_dot2_f32_bf16 v4, v55, s40, v4
    v_mfma_f32_32x32x16_bf16 v[80:95], v[20:23], v[52:55], v[80:95]
    v_dot2_f32_bf16 v5, v52, v52, v5
    v_dot2_f32_bf16 v5, v53, v53, v5
    v_dot2_f32_bf16 v5, v54, v54, v5
    v_dot2_f32_bf16 v5, v55, v55, v5
    v_mfma_f32_32x32x16_bf16 v[96:111], v[24:27], v[52:55], v[96:111]
    ds_read_b128 v[52:55], v61 offset:34816
    ds_read_b64_tr_b16 v[16:17], v43 offset:57344
    ds_read_b64_tr_b16 v[18:19], v43 offset:58368
    ds_read_b64_tr_b16 v[20:21], v44 offset:57344
    ds_read_b64_tr_b16 v[22:23], v44 offset:58368
    ds_read_b64_tr_b16 v[24:25], v45 offset:57344
    ds_read_b64_tr_b16 v[26:27], v45 offset:58368
    s_waitcnt lgkmcnt(7)
    v_mfma_f32_32x32x16_bf16 v[64:79], v[28:31], v[56:59], v[64:79]
    v_dot2_f32_bf16 v4, v56, s40, v4
    v_dot2_f32_bf16 v4, v57, s40, v4
    v_dot2_f32_bf16 v4, v58, s40, v4
    v_dot2_f32_bf16 v4, v59, s40, v4
    v_mfma_f32_32x32x16_bf16 v[80:95], v[32:35], v[56:59], v[80:95]
    v_dot2_f32_bf16 v5, v56, v56, v5
    v_dot2_f32_bf16 v5, v57, v57, v5
    v_dot2_f32_bf16 v5, v58, v58, v5
    v_dot2_f32_bf16 v5, v59, v59, v5
    v_mfma_f32_32x32x16_bf16 v[96:111], v[36:39], v[56:59], v[96:111]
    ds_read_b128 v[56:59], v61 offset:35840
    ds_read_b64_tr_b16 v[28:29], v43 offset:61440
    ds_read_b64_tr_b16 v[30:31], v43 offset:62464
    ds_read_b64_tr_b16 v[32:33], v44 offset:61440
    ds_read_b64_tr_b16 v[34:35], v44 offset:62464
    ds_read_b64_tr_b16 v[36:37], v45 offset:61440
    ds_read_b64_tr_b16 v[38:39], v45 offset:62464
    s_waitcnt lgkmcnt(7)
    v_mfma_f32_32x32x16_bf16 v[64:79], v[16:19], v[52:55], v[64:79]
    v_dot2_f32_bf16 v4, v52, s40, v4
    v_dot2_f32_bf16 v4, v53, s40, v4
    v_dot2_f32_bf16 v4, v54, s40, v4
    v_dot2_f32_bf16 v4, v55, s40, v4
    v_mfma_f32_32x32x16_bf16 v[80:95], v[20:23], v[52:55], v[80:95]
    v_dot2_f32_bf16 v5, v52, v52, v5
    v_dot2_f32_bf16 v5, v53, v53, v5
    v_dot2_f32_bf16 v5, v54, v54, v5
    v_dot2_f32_bf16 v5, v55, v55, v5
    v_mfma_f32_32x32x16_bf16 v[96:111], v[24:27], v[52:55], v[96:111]
    s_waitcnt lgkmcnt(0)
    v_mfma_f32_32x32x16_bf16 v[64:79], v[28:31], v[56:59], v[64:79]
    v_dot2_f32_bf16 v4, v56, s40, v4
    v_dot2_f32_bf16 v4, v57, s40, v4
    v_dot2_f32_bf16 v4, v58, s40, v4
    v_dot2_f32_bf16 v4, v59, s40, v4
    v_mfma_f32_32x32x16_bf16 v[80:95], v[32:35], v[56:59], v[80:95]
    v_dot2_f32_bf16 v5, v56, v56, v5
    v_dot2_f32_bf16 v5, v57, v57, v5
    v_dot2_f32_bf16 v5, v58, v58, v5
    v_dot2_f32_bf16 v5, v59, v59, v5
    v_mfma_f32_32x32x16_bf16 v[96:111], v[36:39], v[56:59], v[96:111]
    s_barrier
    ds_read_b128 v[52:55], v60 offset:0
    ds_read_b64_tr_b16 v[16:17], v40 offset:16384
    ds_read_b64_tr_b16 v[18:19], v40 offset:17408
    ds_read_b64_tr_b16 v[20:21], v41 offset:16384
    ds_read_b64_tr_b16 v[22:23], v41 offset:17408
    ds_read_b64_tr_b16 v[24:25], v42 offset:16384
    ds_read_b64_tr_b16 v[26:27], v42 offset:17408
    ds_read_b128 v[56:59], v60 offset:1024
    ds_read_b64_tr_b16 v[28:29], v40 offset:20480
    ds_read_b64_tr_b16 v[30:31], v40 offset:21504
    ds_read_b64_tr_b16 v[32:33], v41 offset:20480
    ds_read_b64_tr_b16 v[34:35], v41 offset:21504
    ds_read_b64_tr_b16 v[36:37], v42 offset:20480
    ds_read_b64_tr_b16 v[38:39], v42 offset:21504
    s_waitcnt lgkmcnt(7)
    v_mfma_f32_32x32x16_bf16 v[64:79], v[16:19], v[52:55], v[64:79]
    v_dot2_f32_bf16 v4, v52, s40, v4
    v_dot2_f32_bf16 v4, v53, s40, v4
    v_dot2_f32_bf16 v4, v54, s40, v4
    v_dot2_f32_bf16 v4, v55, s40, v4
    v_mfma_f32_32x32x16_bf16 v[80:95], v[20:23], v[52:55], v[80:95]
    v_dot2_f32_bf16 v5, v52, v52, v5
    v_dot2_f32_bf16 v5, v53, v53, v5
    v_dot2_f32_bf16 v5, v54, v54, v5
    v_dot2_f32_bf16 v5, v55, v55, v5
    v_mfma_f32_32x32x16_bf16 v[96:111], v[24:27], v[52:55], v[96:111]
    ds_read_b128 v[52:55], v60 offset:2048
    ds_read_b64_tr_b16 v[16:17], v40 offset:24576
    ds_read_b64_tr_b16 v[18:19], v40 offset:25600
    ds_read_b64_tr_b16 v[20:21], v41 offset:24576
    ds_read_b64_tr_b16 v[22:23], v41 offset:25600
    ds_read_b64_tr_b16 v[24:25], v42 offset:24576
    ds_read_b64_tr_b16 v[26:27], v42 offset:25600
    s_waitcnt lgkmcnt(7)
    v_mfma_f32_32x32x16_bf16 v[64:79], v[28:31], v[56:59], v[64:79]
    v_dot2_f32_bf16 v4, v56, s40, v4
    v_dot2_f32_bf16 v4, v57, s40, v4
    v_dot2_f32_bf16 v4, v58, s40, v4
    v_dot2_f32_bf16 v4, v59, s40, v4
    v_mfma_f32_32x32x16_bf16 v[80:95], v[32:35], v[56:59], v[80:95]
    v_dot2_f32_bf16 v5, v56, v56, v5
    v_dot2_f32_bf16 v5, v57, v57, v5
    v_dot2_f32_bf16 v5, v58, v58, v5
    v_dot2_f32_bf16 v5, v59, v59, v5
    v_mfma_f32_32x32x16_bf16 v[96:111], v[36:39], v[56:59], v[96:111]
    ds_read_b128 v[56:59], v60 offset:3072
    ds_read_b64_tr_b16 v[28:29], v40 offset:28672
    ds_read_b64_tr_b16 v[30:31], v40 offset:29696
    ds_read_b64_tr_b16 v[32:33], v41 offset:28672
    ds_read_b64_tr_b16 v[34:35], v41 offset:29696
    ds_read_b64_tr_b16 v[36:37], v42 offset:28672
    ds_read_b64_tr_b16 v[38:39], v42 offset:29696
    s_waitcnt lgkmcnt(7)
    v_mfma_f32_32x32x16_bf16 v[64:79], v[16:19], v[52:55], v[64:79]
    v_dot2_f32_bf16 v4, v52, s40, v4
    v_dot2_f32_bf16 v4, v53, s40, v4
    v_dot2_f32_bf16 v4, v54, s40, v4
    v_dot2_f32_bf16 v4, v55, s40, v4
    v_mfma_f32_32x32x16_bf16 v[80:95], v[20:23], v[52:55], v[80:95]
    v_dot2_f32_bf16 v5, v52, v52, v5
    v_dot2_f32_bf16 v5, v53, v53, v5
    v_dot2_f32_bf16 v5, v54, v54, v5
    v_dot2_f32_bf16 v5, v55, v55, v5
    v_mfma_f32_32x32x16_bf16 v[96:111], v[24:27], v[52:55], v[96:111]
    s_waitcnt lgkmcnt(0)
    v_mfma_f32_32x32x16_bf16 v[64:79], v[28:31], v[56:59], v[64:79]
    v_dot2_f32_bf16 v4, v56, s40, v4
    v_dot2_f32_bf16 v4, v57, s40, v4
    v_dot2_f32_bf16 v4, v58, s40, v4
    v_dot2_f32_bf16 v4, v59, s40, v4
    v_mfma_f32_32x32x16_bf16 v[80:95], v[32:35], v[56:59], v[80:95]
    v_dot2_f32_bf16 v5, v56, v56, v5
    v_dot2_f32_bf16 v5, v57, v57, v5
    v_dot2_f32_bf16 v5, v58, v58, v5
    v_dot2_f32_bf16 v5, v59, v59, v5
    v_mfma_f32_32x32x16_bf16 v[96:111], v[36:39], v[56:59], v[96:111]
    s_barrier
    ds_read_b128 v[52:55], v60 offset:32768
    ds_read_b64_tr_b16 v[16:17], v40 offset:49152
    ds_read_b64_tr_b16 v[18:19], v40 offset:50176
    ds_read_b64_tr_b16 v[20:21], v41 offset:49152
    ds_read_b64_tr_b16 v[22:23], v41 offset:50176
    ds_read_b64_tr_b16 v[24:25], v42 offset:49152
    ds_read_b64_tr_b16 v[26:27], v42 offset:50176
    ds_read_b128 v[56:59], v60 offset:33792
    ds_read_b64_tr_b16 v[28:29], v40 offset:53248
    ds_read_b64_tr_b16 v[30:31], v40 offset:54272
    ds_read_b64_tr_b16 v[32:33], v41 offset:53248
    ds_read_b64_tr_b16 v[34:35], v41 offset:54272
    ds_read_b64_tr_b16 v[36:37], v42 offset:53248
    ds_read_b64_tr_b16 v[38:39], v42 offset:54272
    s_waitcnt lgkmcnt(7)
    v_mfma_f32_32x32x16_bf16 v[64:79], v[16:19], v[52:55], v[64:79]
    v_dot2_f32_bf16 v4, v52, s40, v4
    v_dot2_f32_bf16 v4, v53, s40, v4
    v_dot2_f32_bf16 v4, v54, s40, v4
    v_dot2_f32_bf16 v4, v55, s40, v4
    v_mfma_f32_32x32x16_bf16 v[80:95], v[20:23], v[52:55], v[80:95]
    v_dot2_f32_bf16 v5, v52, v52, v5
    v_dot2_f32_bf16 v5, v53, v53, v5
    v_dot2_f32_bf16 v5, v54, v54, v5
    v_dot2_f32_bf16 v5, v55, v55, v5
    v_mfma_f32_32x32x16_bf16 v[96:111], v[24:27], v[52:55], v[96:111]
    ds_read_b128 v[52:55], v60 offset:34816
    ds_read_b64_tr_b16 v[16:17], v40 offset:57344
    ds_read_b64_tr_b16 v[18:19], v40 offset:58368
    ds_read_b64_tr_b16 v[20:21], v41 offset:57344
    ds_read_b64_tr_b16 v[22:23], v41 offset:58368
    ds_read_b64_tr_b16 v[24:25], v42 offset:57344
    ds_read_b64_tr_b16 v[26:27], v42 offset:58368
    s_waitcnt lgkmcnt(7)
    v_mfma_f32_32x32x16_bf16 v[64:79], v[28:31], v[56:59], v[64:79]
    v_dot2_f32_bf16 v4, v56, s40, v4
    v_dot2_f32_bf16 v4, v57, s40, v4
    v_dot2_f32_bf16 v4, v58, s40, v4
    v_dot2_f32_bf16 v4, v59, s40, v4
    v_mfma_f32_32x32x16_bf16 v[80:95], v[32:35], v[56:59], v[80:95]
    v_dot2_f32_bf16 v5, v56, v56, v5
    v_dot2_f32_bf16 v5, v57, v57, v5
    v_dot2_f32_bf16 v5, v58, v58, v5
    v_dot2_f32_bf16 v5, v59, v59, v5
    v_mfma_f32_32x32x16_bf16 v[96:111], v[36:39], v[56:59], v[96:111]
    ds_read_b128 v[56:59], v60 offset:35840
    ds_read_b64_tr_b16 v[28:29], v40 offset:61440
    ds_read_b64_tr_b16 v[30:31], v40 offset:62464
    ds_read_b64_tr_b16 v[32:33], v41 offset:61440
    ds_read_b64_tr_b16 v[34:35], v41 offset:62464
    ds_read_b64_tr_b16 v[36:37], v42 offset:61440
    ds_read_b64_tr_b16 v[38:39], v42 offset:62464
    s_waitcnt lgkmcnt(7)
    v_mfma_f32_32x32x16_bf16 v[64:79], v[16:19], v[52:55], v[64:79]
    v_dot2_f32_bf16 v4, v52, s40, v4
    v_dot2_f32_bf16 v4, v53, s40, v4
    v_dot2_f32_bf16 v4, v54, s40, v4
    v_dot2_f32_bf16 v4, v55, s40, v4
    v_mfma_f32_32x32x16_bf16 v[80:95], v[20:23], v[52:55], v[80:95]
    v_dot2_f32_bf16 v5, v52, v52, v5
    v_dot2_f32_bf16 v5, v53, v53, v5
    v_dot2_f32_bf16 v5, v54, v54, v5
    v_dot2_f32_bf16 v5, v55, v55, v5
    v_mfma_f32_32x32x16_bf16 v[96:111], v[24:27], v[52:55], v[96:111]
    s_waitcnt lgkmcnt(0)
    v_mfma_f32_32x32x16_bf16 v[64:79], v[28:31], v[56:59], v[64:79]
    v_dot2_f32_bf16 v4, v56, s40, v4
    v_dot2_f32_bf16 v4, v57, s40, v4
    v_dot2_f32_bf16 v4, v58, s40, v4
    v_dot2_f32_bf16 v4, v59, s40, v4
    v_mfma_f32_32x32x16_bf16 v[80:95], v[32:35], v[56:59], v[80:95]
    v_dot2_f32_bf16 v5, v56, v56, v5
    v_dot2_f32_bf16 v5, v57, v57, v5
    v_dot2_f32_bf16 v5, v58, v58, v5
    v_dot2_f32_bf16 v5, v59, v59, v5
    v_mfma_f32_32x32x16_bf16 v[96:111], v[36:39], v[56:59], v[96:111]
    s_barrier
    ds_read_b128 v[52:55], v61 offset:0
    ds_read_b64_tr_b16 v[16:17], v43 offset:16384
    ds_read_b64_tr_b16 v[18:19], v43 offset:17408
    ds_read_b64_tr_b16 v[20:21], v44 offset:16384
    ds_read_b64_tr_b16 v[22:23], v44 offset:17408
    ds_read_b64_tr_b16 v[24:25], v45 offset:16384
    ds_read_b64_tr_b16 v[26:27], v45 offset:17408
    ds_read_b128 v[56:59], v61 offset:1024
    ds_read_b64_tr_b16 v[28:29], v43 offset:20480
    ds_read_b64_tr_b16 v[30:31], v43 offset:21504
    ds_read_b64_tr_b16 v[32:33], v44 offset:20480
    ds_read_b64_tr_b16 v[34:35], v44 offset:21504
    ds_read_b64_tr_b16 v[36:37], v45 offset:20480
    ds_read_b64_tr_b16 v[38:39], v45 offset:21504
    s_waitcnt lgkmcnt(7)
    v_mfma_f32_32x32x16_bf16 v[64:79], v[16:19], v[52:55], v[64:79]
    v_dot2_f32_bf16 v4, v52, s40, v4
    v_dot2_f32_bf16 v4, v53, s40, v4
    v_dot2_f32_bf16 v4, v54, s40, v4
    v_dot2_f32_bf16 v4, v55, s40, v4
    v_mfma_f32_32x32x16_bf16 v[80:95], v[20:23], v[52:55], v[80:95]
    v_dot2_f32_bf16 v5, v52, v52, v5
    v_dot2_f32_bf16 v5, v53, v53, v5
    v_dot2_f32_bf16 v5, v54, v54, v5
    v_dot2_f32_bf16 v5, v55, v55, v5
    v_mfma_f32_32x32x16_bf16 v[96:111], v[24:27], v[52:55], v[96:111]
    ds_read_b128 v[52:55], v61 offset:2048
    ds_read_b64_tr_b16 v[16:17], v43 offset:24576
    ds_read_b64_tr_b16 v[18:19], v43 offset:25600
    ds_read_b64_tr_b16 v[20:21], v44 offset:24576
    ds_read_b64_tr_b16 v[22:23], v44 offset:25600
    ds_read_b64_tr_b16 v[24:25], v45 offset:24576
    ds_read_b64_tr_b16 v[26:27], v45 offset:25600
    s_waitcnt lgkmcnt(7)
    v_mfma_f32_32x32x16_bf16 v[64:79], v[28:31], v[56:59], v[64:79]
    v_dot2_f32_bf16 v4, v56, s40, v4
    v_dot2_f32_bf16 v4, v57, s40, v4
    v_dot2_f32_bf16 v4, v58, s40, v4
    v_dot2_f32_bf16 v4, v59, s40, v4
    v_mfma_f32_32x32x16_bf16 v[80:95], v[32:35], v[56:59], v[80:95]
    v_dot2_f32_bf16 v5, v56, v56, v5
    v_dot2_f32_bf16 v5, v57, v57, v5
    v_dot2_f32_bf16 v5, v58, v58, v5
    v_dot2_f32_bf16 v5, v59, v59, v5
    v_mfma_f32_32x32x16_bf16 v[96:111], v[36:39], v[56:59], v[96:111]
    ds_read_b128 v[56:59], v61 offset:3072
    ds_read_b64_tr_b16 v[28:29], v43 offset:28672
    ds_read_b64_tr_b16 v[30:31], v43 offset:29696
    ds_read_b64_tr_b16 v[32:33], v44 offset:28672
    ds_read_b64_tr_b16 v[34:35], v44 offset:29696
    ds_read_b64_tr_b16 v[36:37], v45 offset:28672
    ds_read_b64_tr_b16 v[38:39], v45 offset:29696
    s_waitcnt lgkmcnt(7)
    v_mfma_f32_32x32x16_bf16 v[64:79], v[16:19], v[52:55], v[64:79]
    v_dot2_f32_bf16 v4, v52, s40, v4
    v_dot2_f32_bf16 v4, v53, s40, v4
    v_dot2_f32_bf16 v4, v54, s40, v4
    v_dot2_f32_bf16 v4, v55, s40, v4
    v_mfma_f32_32x32x16_bf16 v[80:95], v[20:23], v[52:55], v[80:95]
    v_dot2_f32_bf16 v5, v52, v52, v5
    v_dot2_f32_bf16 v5, v53, v53, v5
    v_dot2_f32_bf16 v5, v54, v54, v5
    v_dot2_f32_bf16 v5, v55, v55, v5
    v_mfma_f32_32x32x16_bf16 v[96:111], v[24:27], v[52:55], v[96:111]
    s_waitcnt lgkmcnt(0)
    v_mfma_f32_32x32x16_bf16 v[64:79], v[28:31], v[56:59], v[64:79]
    v_dot2_f32_bf16 v4, v56, s40, v4
    v_dot2_f32_bf16 v4, v57, s40, v4
    v_dot2_f32_bf16 v4, v58, s40, v4
    v_dot2_f32_bf16 v4, v59, s40, v4
    v_mfma_f32_32x32x16_bf16 v[80:95], v[32:35], v[56:59], v[80:95]
    v_dot2_f32_bf16 v5, v56, v56, v5
    v_dot2_f32_bf16 v5, v57, v57, v5
    v_dot2_f32_bf16 v5, v58, v58, v5
    v_dot2_f32_bf16 v5, v59, v59, v5
    v_mfma_f32_32x32x16_bf16 v[96:111], v[36:39], v[56:59], v[96:111]
    s_barrier
    ds_read_b128 v[52:55], v61 offset:32768
    ds_read_b64_tr_b16 v[16:17], v43 offset:49152
    ds_read_b64_tr_b16 v[18:19], v43 offset:50176
    ds_read_b64_tr_b16 v[20:21], v44 offset:49152
    ds_read_b64_tr_b16 v[22:23], v44 offset:50176
    ds_read_b64_tr_b16 v[24:25], v45 offset:49152
    ds_read_b64_tr_b16 v[26:27], v45 offset:50176
    ds_read_b128 v[56:59], v61 offset:33792
    ds_read_b64_tr_b16 v[28:29], v43 offset:53248
    ds_read_b64_tr_b16 v[30:31], v43 offset:54272
    ds_read_b64_tr_b16 v[32:33], v44 offset:53248
    ds_read_b64_tr_b16 v[34:35], v44 offset:54272
    ds_read_b64_tr_b16 v[36:37], v45 offset:53248
    ds_read_b64_tr_b16 v[38:39], v45 offset:54272
    s_waitcnt lgkmcnt(7)
    v_mfma_f32_32x32x16_bf16 v[64:79], v[16:19], v[52:55], v[64:79]
    v_dot2_f32_bf16 v4, v52, s40, v4
    v_dot2_f32_bf16 v4, v53, s40, v4
    v_dot2_f32_bf16 v4, v54, s40, v4
    v_dot2_f32_bf16 v4, v55, s40, v4
    v_mfma_f32_32x32x16_bf16 v[80:95], v[20:23], v[52:55], v[80:95]
    v_dot2_f32_bf16 v5, v52, v52, v5
    v_dot2_f32_bf16 v5, v53, v53, v5
    v_dot2_f32_bf16 v5, v54, v54, v5
    v_dot2_f32_bf16 v5, v55, v55, v5
    v_mfma_f32_32x32x16_bf16 v[96:111], v[24:27], v[52:55], v[96:111]
    ds_read_b128 v[52:55], v61 offset:34816
    ds_read_b64_tr_b16 v[16:17], v43 offset:57344
    ds_read_b64_tr_b16 v[18:19], v43 offset:58368
    ds_read_b64_tr_b16 v[20:21], v44 offset:57344
    ds_read_b64_tr_b16 v[22:23], v44 offset:58368
    ds_read_b64_tr_b16 v[24:25], v45 offset:57344
    ds_read_b64_tr_b16 v[26:27], v45 offset:58368
    s_waitcnt lgkmcnt(7)
    v_mfma_f32_32x32x16_bf16 v[64:79], v[28:31], v[56:59], v[64:79]
    v_dot2_f32_bf16 v4, v56, s40, v4
    v_dot2_f32_bf16 v4, v57, s40, v4
    v_dot2_f32_bf16 v4, v58, s40, v4
    v_dot2_f32_bf16 v4, v59, s40, v4
    v_mfma_f32_32x32x16_bf16 v[80:95], v[32:35], v[56:59], v[80:95]
    v_dot2_f32_bf16 v5, v56, v56, v5
    v_dot2_f32_bf16 v5, v57, v57, v5
    v_dot2_f32_bf16 v5, v58, v58, v5
    v_dot2_f32_bf16 v5, v59, v59, v5
    v_mfma_f32_32x32x16_bf16 v[96:111], v[36:39], v[56:59], v[96:111]
    ds_read_b128 v[56:59], v61 offset:35840
    ds_read_b64_tr_b16 v[28:29], v43 offset:61440
    ds_read_b64_tr_b16 v[30:31], v43 offset:62464
    ds_read_b64_tr_b16 v[32:33], v44 offset:61440
    ds_read_b64_tr_b16 v[34:35], v44 offset:62464
    ds_read_b64_tr_b16 v[36:37], v45 offset:61440
    ds_read_b64_tr_b16 v[38:39], v45 offset:62464
    s_waitcnt lgkmcnt(7)
    v_mfma_f32_32x32x16_bf16 v[64:79], v[16:19], v[52:55], v[64:79]
    v_dot2_f32_bf16 v4, v52, s40, v4
    v_dot2_f32_bf16 v4, v53, s40, v4
    v_dot2_f32_bf16 v4, v54, s40, v4
    v_dot2_f32_bf16 v4, v55, s40, v4
    v_mfma_f32_32x32x16_bf16 v[80:95], v[20:23], v[52:55], v[80:95]
    v_dot2_f32_bf16 v5, v52, v52, v5
    v_dot2_f32_bf16 v5, v53, v53, v5
    v_dot2_f32_bf16 v5, v54, v54, v5
    v_dot2_f32_bf16 v5, v55, v55, v5
    v_mfma_f32_32x32x16_bf16 v[96:111], v[24:27], v[52:55], v[96:111]
    s_waitcnt lgkmcnt(0)
    v_mfma_f32_32x32x16_bf16 v[64:79], v[28:31], v[56:59], v[64:79]
    v_dot2_f32_bf16 v4, v56, s40, v4
    v_dot2_f32_bf16 v4, v57, s40, v4
    v_dot2_f32_bf16 v4, v58, s40, v4
    v_dot2_f32_bf16 v4, v59, s40, v4
    v_mfma_f32_32x32x16_bf16 v[80:95], v[32:35], v[56:59], v[80:95]
    v_dot2_f32_bf16 v5, v56, v56, v5
    v_dot2_f32_bf16 v5, v57, v57, v5
    v_dot2_f32_bf16 v5, v58, v58, v5
    v_dot2_f32_bf16 v5, v59, v59, v5
    v_mfma_f32_32x32x16_bf16 v[96:111], v[36:39], v[56:59], v[96:111]
    s_nop 15
    s_barrier
    v_mov_b32 v9, v4
    s_nop 1
    v_permlane32_swap_b32 v4, v9
    s_nop 1
    v_add_f32 v4, v4, v9
    v_mov_b32 v9, v5
    s_nop 1
    v_permlane32_swap_b32 v5, v9
    s_nop 1
    v_add_f32 v5, v5, v9
    v_mul_f32 v4, 0x3b000000, v4
    v_mul_f32 v5, 0x3b000000, v5
    v_fma_f32 v5, -v4, v4, v5
    v_max_f32 v5, 0, v5
    v_cvt_pk_bf16_f32 v9, v4, v4
    v_lshlrev_b32 v4, 16, v9
    v_cvt_pk_bf16_f32 v9, v5, v5
    v_lshlrev_b32 v5, 16, v9
    v_add_f32 v5, 0x3727c5ac, v5
    v_cvt_pk_bf16_f32 v9, v5, v5
    v_lshlrev_b32 v5, 16, v9
    v_sqrt_f32 v5, v5
    s_nop 0
    v_cvt_pk_bf16_f32 v9, v5, v5
    v_lshlrev_b32 v5, 16, v9
    v_rcp_f32 v5, v5
    s_nop 0
    v_sub_f32 v46, 0, v4
    v_mov_b32 v47, v46
    v_mov_b32 v48, v5
    v_mov_b32 v49, v5
    v_and_b32 v9, 31, v1
    v_lshlrev_b32 v9, 2, v9
    v_add_u32 v10, 133120, v9
    ds_read_b32 v112, v10 offset:0
    ds_read_b32 v113, v10 offset:128
    ds_read_b32 v114, v10 offset:256
    ds_read_b32 v115, v10 offset:384
    ds_read_b32 v116, v10 offset:512
    ds_read_b32 v117, v10 offset:640
    ds_read_b32 v118, v10 offset:768
    ds_read_b32 v119, v10 offset:896
    ds_read_b32 v120, v10 offset:1024
    ds_read_b32 v121, v10 offset:1152
    ds_read_b32 v122, v10 offset:1280
    ds_read_b32 v123, v10 offset:1408
    ds_read_b32 v124, v10 offset:1536
    ds_read_b32 v125, v10 offset:1664
    ds_read_b32 v126, v10 offset:1792
    ds_read_b32 v127, v10 offset:1920
    ds_read_b32 v128, v10 offset:2048
    ds_read_b32 v129, v10 offset:2176
    ds_read_b32 v130, v10 offset:2304
    ds_read_b32 v131, v10 offset:2432
    ds_read_b32 v132, v10 offset:2560
    ds_read_b32 v133, v10 offset:2688
    ds_read_b32 v134, v10 offset:2816
    ds_read_b32 v135, v10 offset:2944
    s_waitcnt lgkmcnt(0)
    v_add_f32 v6, v112, v115
    v_add_f32 v6, v6, v118
    v_add_f32 v6, v6, v121
    v_add_f32 v6, v6, v124
    v_add_f32 v6, v6, v127
    v_add_f32 v6, v6, v130
    v_add_f32 v6, v6, v133
    v_add_f32 v7, v113, v116
    v_add_f32 v7, v7, v119
    v_add_f32 v7, v7, v122
    v_add_f32 v7, v7, v125
    v_add_f32 v7, v7, v128
    v_add_f32 v7, v7, v131
    v_add_f32 v7, v7, v134
    v_add_f32 v8, v114, v117
    v_add_f32 v8, v8, v120
    v_add_f32 v8, v8, v123
    v_add_f32 v8, v8, v126
    v_add_f32 v8, v8, v129
    v_add_f32 v8, v8, v132
    v_add_f32 v8, v8, v135
    s_lshl_b32 s47, s48, 9
    s_add_u32 s47, s47, 131072
    v_add_u32 v10, s47, v9
    ds_write_b32 v10, v6 offset:0
    ds_write_b32 v10, v7 offset:128
    ds_write_b32 v10, v8 offset:256
    v_lshlrev_b32 v10, 4, v13
    v_add_u32 v10, s47, v10
    s_waitcnt lgkmcnt(0)
    ds_read_b128 v[112:115], v10 offset:0
    ds_read_b128 v[116:119], v10 offset:32
    ds_read_b128 v[120:123], v10 offset:64
    ds_read_b128 v[124:127], v10 offset:96
    ds_read_b128 v[128:131], v10 offset:128
    ds_read_b128 v[132:135], v10 offset:160
    ds_read_b128 v[136:139], v10 offset:192
    ds_read_b128 v[140:143], v10 offset:224
    ds_read_b128 v[144:147], v10 offset:256
    ds_read_b128 v[148:151], v10 offset:288
    ds_read_b128 v[152:155], v10 offset:320
    ds_read_b128 v[156:159], v10 offset:352
    s_waitcnt lgkmcnt(0)
    v_pk_fma_f32 v[64:65], v[112:113], v[46:47], v[64:65]
    v_pk_mul_f32 v[64:65], v[64:65], v[48:49]
    v_pk_fma_f32 v[66:67], v[114:115], v[46:47], v[66:67]
    v_pk_mul_f32 v[66:67], v[66:67], v[48:49]
    v_pk_fma_f32 v[68:69], v[116:117], v[46:47], v[68:69]
    v_pk_mul_f32 v[68:69], v[68:69], v[48:49]
    v_pk_fma_f32 v[70:71], v[118:119], v[46:47], v[70:71]
    v_pk_mul_f32 v[70:71], v[70:71], v[48:49]
    v_pk_fma_f32 v[72:73], v[120:121], v[46:47], v[72:73]
    v_pk_mul_f32 v[72:73], v[72:73], v[48:49]
    v_pk_fma_f32 v[74:75], v[122:123], v[46:47], v[74:75]
    v_pk_mul_f32 v[74:75], v[74:75], v[48:49]
    v_pk_fma_f32 v[76:77], v[124:125], v[46:47], v[76:77]
    v_pk_mul_f32 v[76:77], v[76:77], v[48:49]
    v_pk_fma_f32 v[78:79], v[126:127], v[46:47], v[78:79]
    v_pk_mul_f32 v[78:79], v[78:79], v[48:49]
    v_cvt_pk_bf16_f32 v64, v64, v65
    v_cvt_pk_bf16_f32 v65, v66, v67
    v_cvt_pk_bf16_f32 v66, v68, v69
    v_cvt_pk_bf16_f32 v67, v70, v71
    v_cvt_pk_bf16_f32 v68, v72, v73
    v_cvt_pk_bf16_f32 v69, v74, v75
    v_cvt_pk_bf16_f32 v70, v76, v77
    v_cvt_pk_bf16_f32 v71, v78, v79
    v_pk_max_i16 v64, v64, 0
    v_pk_max_i16 v65, v65, 0
    v_pk_max_i16 v66, v66, 0
    v_pk_max_i16 v67, v67, 0
    v_pk_max_i16 v68, v68, 0
    v_pk_max_i16 v69, v69, 0
    v_pk_max_i16 v70, v70, 0
    v_pk_max_i16 v71, v71, 0
    s_nop 1
    v_permlane32_swap_b32 v64, v66
    v_permlane32_swap_b32 v65, v67
    v_permlane32_swap_b32 v68, v70
    v_permlane32_swap_b32 v69, v71
    s_nop 1
    s_mul_i32 s36, s25, 3
    s_add_u32 s36, s36, 0
    s_cmp_ge_u32 s36, 43
    s_cbranch_scc1 L_kw1_kernel_skip0
    s_lshl_b32 s36, s36, 11
    s_mul_i32 s37, s50, 88064
    s_add_u32 s36, s36, s37
    v_lshlrev_b32 v11, 4, v1
    buffer_store_dwordx4 v[64:67], v11, s[32:35], s36 offen
    buffer_store_dwordx4 v[68:71], v11, s[32:35], s36 offen offset:1024
L_kw1_kernel_skip0:
    v_pk_fma_f32 v[80:81], v[128:129], v[46:47], v[80:81]
    v_pk_mul_f32 v[80:81], v[80:81], v[48:49]
    v_pk_fma_f32 v[82:83], v[130:131], v[46:47], v[82:83]
    v_pk_mul_f32 v[82:83], v[82:83], v[48:49]
    v_pk_fma_f32 v[84:85], v[132:133], v[46:47], v[84:85]
    v_pk_mul_f32 v[84:85], v[84:85], v[48:49]
    v_pk_fma_f32 v[86:87], v[134:135], v[46:47], v[86:87]
    v_pk_mul_f32 v[86:87], v[86:87], v[48:49]
    v_pk_fma_f32 v[88:89], v[136:137], v[46:47], v[88:89]
    v_pk_mul_f32 v[88:89], v[88:89], v[48:49]
    v_pk_fma_f32 v[90:91], v[138:139], v[46:47], v[90:91]
    v_pk_mul_f32 v[90:91], v[90:91], v[48:49]
    v_pk_fma_f32 v[92:93], v[140:141], v[46:47], v[92:93]
    v_pk_mul_f32 v[92:93], v[92:93], v[48:49]
    v_pk_fma_f32 v[94:95], v[142:143], v[46:47], v[94:95]
    v_pk_mul_f32 v[94:95], v[94:95], v[48:49]
    v_cvt_pk_bf16_f32 v80, v80, v81
    v_cvt_pk_bf16_f32 v81, v82, v83
    v_cvt_pk_bf16_f32 v82, v84, v85
    v_cvt_pk_bf16_f32 v83, v86, v87
    v_cvt_pk_bf16_f32 v84, v88, v89
    v_cvt_pk_bf16_f32 v85, v90, v91
    v_cvt_pk_bf16_f32 v86, v92, v93
    v_cvt_pk_bf16_f32 v87, v94, v95
    v_pk_max_i16 v80, v80, 0
    v_pk_max_i16 v81, v81, 0
    v_pk_max_i16 v82, v82, 0
    v_pk_max_i16 v83, v83, 0
    v_pk_max_i16 v84, v84, 0
    v_pk_max_i16 v85, v85, 0
    v_pk_max_i16 v86, v86, 0
    v_pk_max_i16 v87, v87, 0
    s_nop 1
    v_permlane32_swap_b32 v80, v82
    v_permlane32_swap_b32 v81, v83
    v_permlane32_swap_b32 v84, v86
    v_permlane32_swap_b32 v85, v87
    s_nop 1
    s_mul_i32 s36, s25, 3
    s_add_u32 s36, s36, 1
    s_cmp_ge_u32 s36, 43
    s_cbranch_scc1 L_kw1_kernel_skip1
    s_lshl_b32 s36, s36, 11
    s_mul_i32 s37, s50, 88064
    s_add_u32 s36, s36, s37
    v_lshlrev_b32 v11, 4, v1
    buffer_store_dwordx4 v[80:83], v11, s[32:35], s36 offen
    buffer_store_dwordx4 v[84:87], v11, s[32:35], s36 offen offset:1024
L_kw1_kernel_skip1:
    v_pk_fma_f32 v[96:97], v[144:145], v[46:47], v[96:97]
    v_pk_mul_f32 v[96:97], v[96:97], v[48:49]
    v_pk_fma_f32 v[98:99], v[146:147], v[46:47], v[98:99]
    v_pk_mul_f32 v[98:99], v[98:99], v[48:49]
    v_pk_fma_f32 v[100:101], v[148:149], v[46:47], v[100:101]
    v_pk_mul_f32 v[100:101], v[100:101], v[48:49]
    v_pk_fma_f32 v[102:103], v[150:151], v[46:47], v[102:103]
    v_pk_mul_f32 v[102:103], v[102:103], v[48:49]
    v_pk_fma_f32 v[104:105], v[152:153], v[46:47], v[104:105]
    v_pk_mul_f32 v[104:105], v[104:105], v[48:49]
    v_pk_fma_f32 v[106:107], v[154:155], v[46:47], v[106:107]
    v_pk_mul_f32 v[106:107], v[106:107], v[48:49]
    v_pk_fma_f32 v[108:109], v[156:157], v[46:47], v[108:109]
    v_pk_mul_f32 v[108:109], v[108:109], v[48:49]
    v_pk_fma_f32 v[110:111], v[158:159], v[46:47], v[110:111]
    v_pk_mul_f32 v[110:111], v[110:111], v[48:49]
    v_cvt_pk_bf16_f32 v96, v96, v97
    v_cvt_pk_bf16_f32 v97, v98, v99
    v_cvt_pk_bf16_f32 v98, v100, v101
    v_cvt_pk_bf16_f32 v99, v102, v103
    v_cvt_pk_bf16_f32 v100, v104, v105
    v_cvt_pk_bf16_f32 v101, v106, v107
    v_cvt_pk_bf16_f32 v102, v108, v109
    v_cvt_pk_bf16_f32 v103, v110, v111
    v_pk_max_i16 v96, v96, 0
    v_pk_max_i16 v97, v97, 0
    v_pk_max_i16 v98, v98, 0
    v_pk_max_i16 v99, v99, 0
    v_pk_max_i16 v100, v100, 0
    v_pk_max_i16 v101, v101, 0
    v_pk_max_i16 v102, v102, 0
    v_pk_max_i16 v103, v103, 0
    s_nop 1
    v_permlane32_swap_b32 v96, v98
    v_permlane32_swap_b32 v97, v99
    v_permlane32_swap_b32 v100, v102
    v_permlane32_swap_b32 v101, v103
    s_nop 1
    s_mul_i32 s36, s25, 3
    s_add_u32 s36, s36, 2
    s_cmp_ge_u32 s36, 43
    s_cbranch_scc1 L_kw1_kernel_skip2
    s_lshl_b32 s36, s36, 11
    s_mul_i32 s37, s50, 88064
    s_add_u32 s36, s36, s37
    v_lshlrev_b32 v11, 4, v1
    buffer_store_dwordx4 v[96:99], v11, s[32:35], s36 offen
    buffer_store_dwordx4 v[100:103], v11, s[32:35], s36 offen offset:1024
L_kw1_kernel_skip2:
    s_waitcnt vmcnt(0)
L_kw1_kernel_end:
    s_endpgm
.globl kw2_kernel
.p2align 8
.type kw2_kernel,@function
kw2_kernel:
    s_cmp_ge_u32 s2, 256
    s_cbranch_scc1 L_kw2_kernel_end
    s_load_dwordx2 s[4:5], s[0:1], 0
    s_load_dwordx2 s[6:7], s[0:1], 40
    s_load_dwordx4 s[8:11], s[0:1], 56
    s_load_dwordx2 s[54:55], s[0:1], 48
    s_and_b32 s24, s2, 7
    s_lshr_b32 s25, s2, 3
    s_and_b32 s26, s25, 3
    s_lshl_b32 s24, s24, 2
    s_add_u32 s24, s24, s26
    s_lshr_b32 s25, s25, 2
    s_lshl_b32 s50, s24, 1
    v_and_b32 v1, 63, v0
    v_lshrrev_b32 v9, 6, v0
    s_nop 0
    v_readfirstlane_b32 s26, v9
    v_lshrrev_b32 v13, 5, v1
    s_and_b32 s48, s26, 3
    s_lshr_b32 s57, s26, 2
    s_cmp_ge_u32 s26, 8
    s_cbranch_scc1 L_kw2_kernel_compute
    v_lshrrev_b32 v9, 3, v1
    v_and_b32 v10, 7, v1
    v_bfe_u32 v11, v1, 4, 1
    v_lshlrev_b32 v11, 2, v11
    v_xor_b32 v10, v10, v11
    v_lshlrev_b32 v3, 10, v9
    s_lshl_b32 s36, s25, 7
    v_lshlrev_b32 v11, 4, v10
    v_add_u32 v11, s36, v11
    v_add_u32 v3, v3, v11
    v_lshlrev_b32 v2, 4, v1
    s_lshr_b32 s52, s48, 1
    s_add_u32 s51, s50, s52
    s_mul_i32 s51, s51, 88064
    s_and_b32 s52, s48, 1
    s_lshl_b32 s52, s52, 12
    s_add_u32 s51, s51, s52
    s_lshl_b32 s53, s48, 12
    s_mul_i32 s43, s48, 32768
    s_waitcnt lgkmcnt(0)
    s_mov_b32 s16, s6
    s_and_b32 s17, s7, 0xffff
    s_mov_b32 s18, 1409024
    s_mov_b32 s19, 0x00020000
    s_add_u32 s12, s10, 16777216
    s_addc_u32 s13, s11, 0
    s_and_b32 s13, s13, 0xffff
    s_mov_b32 s14, 5636096
    s_mov_b32 s15, 0x00020000
    s_lshl_b32 s58, s57, 11
    s_add_u32 s53, s53, s58
    s_lshl_b32 s59, s57, 11
    s_add_u32 s51, s51, s59
    s_mul_i32 s59, s57, 16384
    s_add_u32 s43, s43, s59
    s_add_u32 s44, s53, 0
    s_mov_b32 m0, s44
    s_add_u32 s45, s51, 0
    buffer_load_dwordx4 v2, s[12:15], s45 offen lds
    s_add_u32 s44, s53, 1024
    s_mov_b32 m0, s44
    s_add_u32 s45, s51, 1024
    buffer_load_dwordx4 v2, s[12:15], s45 offen lds
    s_add_u32 s44, s53, 16384
    s_mov_b32 m0, s44
    s_add_u32 s45, s43, 0
    buffer_load_dwordx4 v3, s[16:19], s45 offen lds
    s_add_u32 s44, s53, 17408
    s_mov_b32 m0, s44
    s_add_u32 s45, s43, 8192
    buffer_load_dwordx4 v3, s[16:19], s45 offen lds
    s_barrier
    s_add_u32 s44, s53, 32768
    s_mov_b32 m0, s44
    s_add_u32 s45, s51, 8192
    buffer_load_dwordx4 v2, s[12:15], s45 offen lds
    s_add_u32 s44, s53, 33792
    s_mov_b32 m0, s44
    s_add_u32 s45, s51, 9216
    buffer_load_dwordx4 v2, s[12:15], s45 offen lds
    s_add_u32 s44, s53, 49152
    s_mov_b32 m0, s44
    s_add_u32 s45, s43, 131072
    buffer_load_dwordx4 v3, s[16:19], s45 offen lds
    s_add_u32 s44, s53, 50176
    s_mov_b32 m0, s44
    s_add_u32 s45, s43, 139264
    buffer_load_dwordx4 v3, s[16:19], s45 offen lds
    s_barrier
    s_add_u32 s44, s53, 65536
    s_mov_b32 m0, s44
    s_add_u32 s45, s51, 16384
    buffer_load_dwordx4 v2, s[12:15], s45 offen lds
    s_add_u32 s44, s53, 66560
    s_mov_b32 m0, s44
    s_add_u32 s45, s51, 17408
    buffer_load_dwordx4 v2, s[12:15], s45 offen lds
    s_add_u32 s44, s53, 81920
    s_mov_b32 m0, s44
    s_add_u32 s45, s43, 262144
    buffer_load_dwordx4 v3, s[16:19], s45 offen lds
    s_add_u32 s44, s53, 82944
    s_mov_b32 m0, s44
    s_add_u32 s45, s43, 270336
    buffer_load_dwordx4 v3, s[16:19], s45 offen lds
    s_waitcnt vmcnt(8)
    s_barrier
    s_add_u32 s44, s53, 98304
    s_mov_b32 m0, s44
    s_add_u32 s45, s51, 24576
    buffer_load_dwordx4 v2, s[12:15], s45 offen lds
    s_add_u32 s44, s53, 99328
    s_mov_b32 m0, s44
    s_add_u32 s45, s51, 25600
    buffer_load_dwordx4 v2, s[12:15], s45 offen lds
    s_add_u32 s44, s53, 114688
    s_mov_b32 m0, s44
    s_add_u32 s45, s43, 393216
    buffer_load_dwordx4 v3, s[16:19], s45 offen lds
    s_add_u32 s44, s53, 115712
    s_mov_b32 m0, s44
    s_add_u32 s45, s43, 401408
    buffer_load_dwordx4 v3, s[16:19], s45 offen lds
    s_waitcnt vmcnt(8)
    s_barrier
    s_add_u32 s44, s53, 0
    s_mov_b32 m0, s44
    s_add_u32 s45, s51, 32768
    buffer_load_dwordx4 v2, s[12:15], s45 offen lds
    s_add_u32 s44, s53, 1024
    s_mov_b32 m0, s44
    s_add_u32 s45, s51, 33792
    buffer_load_dwordx4 v2, s[12:15], s45 offen lds
    s_add_u32 s44, s53, 16384
    s_mov_b32 m0, s44
    s_add_u32 s45, s43, 524288
    buffer_load_dwordx4 v3, s[16:19], s45 offen lds
    s_add_u32 s44, s53, 17408
    s_mov_b32 m0, s44
    s_add_u32 s45, s43, 532480
    buffer_load_dwordx4 v3, s[16:19], s45 offen lds
    s_waitcnt vmcnt(8)
    s_barrier
    s_add_u32 s44, s53, 32768
    s_mov_b32 m0, s44
    s_add_u32 s45, s51, 40960
    buffer_load_dwordx4 v2, s[12:15], s45 offen lds
    s_add_u32 s44, s53, 33792
    s_mov_b32 m0, s44
    s_add_u32 s45, s51, 41984
    buffer_load_dwordx4 v2, s[12:15], s45 offen lds
    s_add_u32 s44, s53, 49152
    s_mov_b32 m0, s44
    s_add_u32 s45, s43, 655360
    buffer_load_dwordx4 v3, s[16:19], s45 offen lds
    s_add_u32 s44, s53, 50176
    s_mov_b32 m0, s44
    s_add_u32 s45, s43, 663552
    buffer_load_dwordx4 v3, s[16:19], s45 offen lds
    s_waitcnt vmcnt(8)
    s_barrier
    s_add_u32 s44, s53, 65536
    s_mov_b32 m0, s44
    s_add_u32 s45, s51, 49152
    buffer_load_dwordx4 v2, s[12:15], s45 offen lds
    s_add_u32 s44, s53, 66560
    s_mov_b32 m0, s44
    s_add_u32 s45, s51, 50176
    buffer_load_dwordx4 v2, s[12:15], s45 offen lds
    s_add_u32 s44, s53, 81920
    s_mov_b32 m0, s44
    s_add_u32 s45, s43, 786432
    buffer_load_dwordx4 v3, s[16:19], s45 offen lds
    s_add_u32 s44, s53, 82944
    s_mov_b32 m0, s44
    s_add_u32 s45, s43, 794624
    buffer_load_dwordx4 v3, s[16:19], s45 offen lds
    s_waitcnt vmcnt(8)
    s_barrier
    s_add_u32 s44, s53, 98304
    s_mov_b32 m0, s44
    s_add_u32 s45, s51, 57344
    buffer_load_dwordx4 v2, s[12:15], s45 offen lds
    s_add_u32 s44, s53, 99328
    s_mov_b32 m0, s44
    s_add_u32 s45, s51, 58368
    buffer_load_dwordx4 v2, s[12:15], s45 offen lds
    s_add_u32 s44, s53, 114688
    s_mov_b32 m0, s44
    s_add_u32 s45, s43, 917504
    buffer_load_dwordx4 v3, s[16:19], s45 offen lds
    s_add_u32 s44, s53, 115712
    s_mov_b32 m0, s44
    s_add_u32 s45, s43, 925696
    buffer_load_dwordx4 v3, s[16:19], s45 offen lds
    s_waitcnt vmcnt(8)
    s_barrier
    s_add_u32 s44, s53, 0
    s_mov_b32 m0, s44
    s_add_u32 s45, s51, 65536
    buffer_load_dwordx4 v2, s[12:15], s45 offen lds
    s_add_u32 s44, s53, 1024
    s_mov_b32 m0, s44
    s_add_u32 s45, s51, 66560
    buffer_load_dwordx4 v2, s[12:15], s45 offen lds
    s_add_u32 s44, s53, 16384
    s_mov_b32 m0, s44
    s_add_u32 s45, s43, 1048576
    buffer_load_dwordx4 v3, s[16:19], s45 offen lds
    s_add_u32 s44, s53, 17408
    s_mov_b32 m0, s44
    s_add_u32 s45, s43, 1056768
    buffer_load_dwordx4 v3, s[16:19], s45 offen lds
    s_waitcnt vmcnt(8)
    s_barrier
    s_add_u32 s44, s53, 32768
    s_mov_b32 m0, s44
    s_add_u32 s45, s51, 73728
    buffer_load_dwordx4 v2, s[12:15], s45 offen lds
    s_add_u32 s44, s53, 33792
    s_mov_b32 m0, s44
    s_add_u32 s45, s51, 74752
    buffer_load_dwordx4 v2, s[12:15], s45 offen lds
    s_add_u32 s44, s53, 49152
    s_mov_b32 m0, s44
    s_add_u32 s45, s43, 1179648
    buffer_load_dwordx4 v3, s[16:19], s45 offen lds
    s_add_u32 s44, s53, 50176
    s_mov_b32 m0, s44
    s_add_u32 s45, s43, 1187840
    buffer_load_dwordx4 v3, s[16:19], s45 offen lds
    s_waitcnt vmcnt(8)
    s_barrier
    s_add_u32 s44, s53, 65536
    s_mov_b32 m0, s44
    s_add_u32 s45, s51, 81920
    buffer_load_dwordx4 v2, s[12:15], s45 offen lds
    s_add_u32 s44, s53, 66560
    s_mov_b32 m0, s44
    s_add_u32 s45, s51, 82944
    buffer_load_dwordx4 v2, s[12:15], s45 offen lds
    s_add_u32 s44, s53, 81920
    s_mov_b32 m0, s44
    s_add_u32 s45, s43, 1310720
    buffer_load_dwordx4 v3, s[16:19], s45 offen lds
    s_add_u32 s44, s53, 82944
    s_mov_b32 m0, s44
    s_add_u32 s45, s43, 1318912
    buffer_load_dwordx4 v3, s[16:19], s45 offen lds
    s_waitcnt vmcnt(8)
    s_barrier
    s_waitcnt vmcnt(4)
    s_barrier
    s_waitcnt vmcnt(0)
    s_barrier
    s_branch L_kw2_kernel_end
L_kw2_kernel_compute:
    s_and_b32 s42, s48, 1
    s_add_u32 s50, s50, s42
    s_lshr_b32 s49, s48, 1
    s_lshl_b32 s27, s50, 5
    v_and_b32 v9, 31, v1
    v_add_u32 v14, s27, v9
    v_lshlrev_b32 v60, 4, v1
    s_mul_i32 s36, s42, 8192
    v_add_u32 v60, s36, v60
    v_lshrrev_b32 v9, 2, v1
    v_and_b32 v9, 3, v9
    v_lshlrev_b32 v10, 3, v13
    v_add_u32 v10, v10, v9
    v_lshlrev_b32 v10, 7, v10
    v_lshrrev_b32 v11, 4, v1
    v_and_b32 v11, 1, v11
    v_lshlrev_b32 v11, 5, v11
    v_and_b32 v12, 3, v1
    v_lshlrev_b32 v12, 3, v12
    v_add_u32 v10, v10, v11
    v_add_u32 v10, v10, v12
    v_lshrrev_b32 v11, 1, v9
    v_xor_b32 v11, s49, v11
    v_lshlrev_b32 v11, 6, v11
    v_add_u32 v40, v10, v11
    v_add_u32 v43, 65536, v40
    v_add_u32 v61, 65536, v60
    s_mov_b32 s40, 0x3f803f80
    s_waitcnt lgkmcnt(0)
    s_mov_b32 s20, s10
    s_and_b32 s21, s11, 0xffff
    s_mov_b32 s22, 33554432
    s_mov_b32 s23, 0x00020000
    s_add_u32 s28, s10, 12582912
    s_addc_u32 s29, s11, 0
    s_and_b32 s29, s29, 0xffff
    s_mov_b32 s30, 2097152
    s_mov_b32 s31, 0x00020000
    s_mov_b32 s32, s54
    s_and_b32 s33, s55, 0xffff
    s_mov_b32 s34, 2097152
    s_mov_b32 s35, 0x00020000
    s_lshl_b32 s37, s25, 1
    s_add_u32 s37, s37, s49
    s_lshl_b32 s36, s50, 15
    s_lshl_b32 s41, s37, 11
    s_add_u32 s36, s36, s41
    v_lshlrev_b32 v46, 4, v1
    v_add_u32 v46, s36, v46
    v_lshlrev_b32 v9, 10, v14
    v_lshlrev_b32 v10, 4, v13
    v_add_u32 v9, v9, v10
    s_lshl_b32 s36, s37, 6
    v_add_u32 v47, s36, v9
    buffer_load_dwordx4 v[112:115], v46, s[28:31], 0 offen
    buffer_load_dwordx4 v[116:119], v46, s[28:31], 0 offen offset:1024
    s_barrier
    s_barrier
    s_barrier
    ds_read_b128 v[52:55], v60 offset:0
    ds_read_b64_tr_b16 v[16:17], v40 offset:16384
    ds_read_b64_tr_b16 v[18:19], v40 offset:16896
    ds_read_b128 v[56:59], v60 offset:1024
    ds_read_b64_tr_b16 v[20:21], v40 offset:18432
    ds_read_b64_tr_b16 v[22:23], v40 offset:18944
    s_waitcnt lgkmcnt(3)
    v_mfma_f32_32x32x16_bf16 v[64:79], v[16:19], v[52:55], 0
    ds_read_b128 v[52:55], v60 offset:2048
    ds_read_b64_tr_b16 v[16:17], v40 offset:20480
    ds_read_b64_tr_b16 v[18:19], v40 offset:20992
    s_waitcnt lgkmcnt(3)
    v_mfma_f32_32x32x16_bf16 v[64:79], v[20:23], v[56:59], v[64:79]
    ds_read_b128 v[56:59], v60 offset:3072
    ds_read_b64_tr_b16 v[20:21], v40 offset:22528
    ds_read_b64_tr_b16 v[22:23], v40 offset:23040
    s_waitcnt lgkmcnt(3)
    v_mfma_f32_32x32x16_bf16 v[64:79], v[16:19], v[52:55], v[64:79]
    ds_read_b128 v[52:55], v60 offset:4096
    ds_read_b64_tr_b16 v[16:17], v40 offset:24576
    ds_read_b64_tr_b16 v[18:19], v40 offset:25088
    s_waitcnt lgkmcnt(3)
    v_mfma_f32_32x32x16_bf16 v[64:79], v[20:23], v[56:59], v[64:79]
    ds_read_b128 v[56:59], v60 offset:5120
    ds_read_b64_tr_b16 v[20:21], v40 offset:26624
    ds_read_b64_tr_b16 v[22:23], v40 offset:27136
    s_waitcnt lgkmcnt(3)
    v_mfma_f32_32x32x16_bf16 v[64:79], v[16:19], v[52:55], v[64:79]
    ds_read_b128 v[52:55], v60 offset:6144
    ds_read_b64_tr_b16 v[16:17], v40 offset:28672
    ds_read_b64_tr_b16 v[18:19], v40 offset:29184
    s_waitcnt lgkmcnt(3)
    v_mfma_f32_32x32x16_bf16 v[64:79], v[20:23], v[56:59], v[64:79]
    ds_read_b128 v[56:59], v60 offset:7168
    ds_read_b64_tr_b16 v[20:21], v40 offset:30720
    ds_read_b64_tr_b16 v[22:23], v40 offset:31232
    s_waitcnt lgkmcnt(3)
    v_mfma_f32_32x32x16_bf16 v[64:79], v[16:19], v[52:55], v[64:79]
    s_waitcnt lgkmcnt(0)
    v_mfma_f32_32x32x16_bf16 v[64:79], v[20:23], v[56:59], v[64:79]
    s_barrier
    ds_read_b128 v[52:55], v60 offset:32768
    ds_read_b64_tr_b16 v[16:17], v40 offset:49152
    ds_read_b64_tr_b16 v[18:19], v40 offset:49664
    ds_read_b128 v[56:59], v60 offset:33792
    ds_read_b64_tr_b16 v[20:21], v40 offset:51200
    ds_read_b64_tr_b16 v[22:23], v40 offset:51712
    s_waitcnt lgkmcnt(3)
    v_mfma_f32_32x32x16_bf16 v[64:79], v[16:19], v[52:55], v[64:79]
    ds_read_b128 v[52:55], v60 offset:34816
    ds_read_b64_tr_b16 v[16:17], v40 offset:53248
    ds_read_b64_tr_b16 v[18:19], v40 offset:53760
    s_waitcnt lgkmcnt(3)
    v_mfma_f32_32x32x16_bf16 v[64:79], v[20:23], v[56:59], v[64:79]
    ds_read_b128 v[56:59], v60 offset:35840
    ds_read_b64_tr_b16 v[20:21], v40 offset:55296
    ds_read_b64_tr_b16 v[22:23], v40 offset:55808
    s_waitcnt lgkmcnt(3)
    v_mfma_f32_32x32x16_bf16 v[64:79], v[16:19], v[52:55], v[64:79]
    ds_read_b128 v[52:55], v60 offset:36864
    ds_read_b64_tr_b16 v[16:17], v40 offset:57344
    ds_read_b64_tr_b16 v[18:19], v40 offset:57856
    s_waitcnt lgkmcnt(3)
    v_mfma_f32_32x32x16_bf16 v[64:79], v[20:23], v[56:59], v[64:79]
    ds_read_b128 v[56:59], v60 offset:37888
    ds_read_b64_tr_b16 v[20:21], v40 offset:59392
    ds_read_b64_tr_b16 v[22:23], v40 offset:59904
    s_waitcnt lgkmcnt(3)
    v_mfma_f32_32x32x16_bf16 v[64:79], v[16:19], v[52:55], v[64:79]
    ds_read_b128 v[52:55], v60 offset:38912
    ds_read_b64_tr_b16 v[16:17], v40 offset:61440
    ds_read_b64_tr_b16 v[18:19], v40 offset:61952
    s_waitcnt lgkmcnt(3)
    v_mfma_f32_32x32x16_bf16 v[64:79], v[20:23], v[56:59], v[64:79]
    ds_read_b128 v[56:59], v60 offset:39936
    ds_read_b64_tr_b16 v[20:21], v40 offset:63488
    ds_read_b64_tr_b16 v[22:23], v40 offset:64000
    s_waitcnt lgkmcnt(3)
    v_mfma_f32_32x32x16_bf16 v[64:79], v[16:19], v[52:55], v[64:79]
    s_waitcnt lgkmcnt(0)
    v_mfma_f32_32x32x16_bf16 v[64:79], v[20:23], v[56:59], v[64:79]
    s_barrier
    ds_read_b128 v[52:55], v61 offset:0
    ds_read_b64_tr_b16 v[16:17], v43 offset:16384
    ds_read_b64_tr_b16 v[18:19], v43 offset:16896
    ds_read_b128 v[56:59], v61 offset:1024
    ds_read_b64_tr_b16 v[20:21], v43 offset:18432
    ds_read_b64_tr_b16 v[22:23], v43 offset:18944
    s_waitcnt lgkmcnt(3)
    v_mfma_f32_32x32x16_bf16 v[64:79], v[16:19], v[52:55], v[64:79]
    ds_read_b128 v[52:55], v61 offset:2048
    ds_read_b64_tr_b16 v[16:17], v43 offset:20480
    ds_read_b64_tr_b16 v[18:19], v43 offset:20992
    s_waitcnt lgkmcnt(3)
    v_mfma_f32_32x32x16_bf16 v[64:79], v[20:23], v[56:59], v[64:79]
    ds_read_b128 v[56:59], v61 offset:3072
    ds_read_b64_tr_b16 v[20:21], v43 offset:22528
    ds_read_b64_tr_b16 v[22:23], v43 offset:23040
    s_waitcnt lgkmcnt(3)
    v_mfma_f32_32x32x16_bf16 v[64:79], v[16:19], v[52:55], v[64:79]
    ds_read_b128 v[52:55], v61 offset:4096
    ds_read_b64_tr_b16 v[16:17], v43 offset:24576
    ds_read_b64_tr_b16 v[18:19], v43 offset:25088
    s_waitcnt lgkmcnt(3)
    v_mfma_f32_32x32x16_bf16 v[64:79], v[20:23], v[56:59], v[64:79]
    ds_read_b128 v[56:59], v61 offset:5120
    ds_read_b64_tr_b16 v[20:21], v43 offset:26624
    ds_read_b64_tr_b16 v[22:23], v43 offset:27136
    s_waitcnt lgkmcnt(3)
    v_mfma_f32_32x32x16_bf16 v[64:79], v[16:19], v[52:55], v[64:79]
    ds_read_b128 v[52:55], v61 offset:6144
    ds_read_b64_tr_b16 v[16:17], v43 offset:28672
    ds_read_b64_tr_b16 v[18:19], v43 offset:29184
    s_waitcnt lgkmcnt(3)
    v_mfma_f32_32x32x16_bf16 v[64:79], v[20:23], v[56:59], v[64:79]
    ds_read_b128 v[56:59], v61 offset:7168
    ds_read_b64_tr_b16 v[20:21], v43 offset:30720
    ds_read_b64_tr_b16 v[22:23], v43 offset:31232
    s_waitcnt lgkmcnt(3)
    v_mfma_f32_32x32x16_bf16 v[64:79], v[16:19], v[52:55], v[64:79]
    s_waitcnt lgkmcnt(0)
    v_mfma_f32_32x32x16_bf16 v[64:79], v[20:23], v[56:59], v[64:79]
    s_barrier
    ds_read_b128 v[52:55], v61 offset:32768
    ds_read_b64_tr_b16 v[16:17], v43 offset:49152
    ds_read_b64_tr_b16 v[18:19], v43 offset:49664
    ds_read_b128 v[56:59], v61 offset:33792
    ds_read_b64_tr_b16 v[20:21], v43 offset:51200
    ds_read_b64_tr_b16 v[22:23], v43 offset:51712
    s_waitcnt lgkmcnt(3)
    v_mfma_f32_32x32x16_bf16 v[64:79], v[16:19], v[52:55], v[64:79]
    ds_read_b128 v[52:55], v61 offset:34816
    ds_read_b64_tr_b16 v[16:17], v43 offset:53248
    ds_read_b64_tr_b16 v[18:19], v43 offset:53760
    s_waitcnt lgkmcnt(3)
    v_mfma_f32_32x32x16_bf16 v[64:79], v[20:23], v[56:59], v[64:79]
    ds_read_b128 v[56:59], v61 offset:35840
    ds_read_b64_tr_b16 v[20:21], v43 offset:55296
    ds_read_b64_tr_b16 v[22:23], v43 offset:55808
    s_waitcnt lgkmcnt(3)
    v_mfma_f32_32x32x16_bf16 v[64:79], v[16:19], v[52:55], v[64:79]
    ds_read_b128 v[52:55], v61 offset:36864
    ds_read_b64_tr_b16 v[16:17], v43 offset:57344
    ds_read_b64_tr_b16 v[18:19], v43 offset:57856
    s_waitcnt lgkmcnt(3)
    v_mfma_f32_32x32x16_bf16 v[64:79], v[20:23], v[56:59], v[64:79]
    ds_read_b128 v[56:59], v61 offset:37888
    ds_read_b64_tr_b16 v[20:21], v43 offset:59392
    ds_read_b64_tr_b16 v[22:23], v43 offset:59904
    s_waitcnt lgkmcnt(3)
    v_mfma_f32_32x32x16_bf16 v[64:79], v[16:19], v[52:55], v[64:79]
    ds_read_b128 v[52:55], v61 offset:38912
    ds_read_b64_tr_b16 v[16:17], v43 offset:61440
    ds_read_b64_tr_b16 v[18:19], v43 offset:61952
    s_waitcnt lgkmcnt(3)
    v_mfma_f32_32x32x16_bf16 v[64:79], v[20:23], v[56:59], v[64:79]
    ds_read_b128 v[56:59], v61 offset:39936
    ds_read_b64_tr_b16 v[20:21], v43 offset:63488
    ds_read_b64_tr_b16 v[22:23], v43 offset:64000
    s_waitcnt lgkmcnt(3)
    v_mfma_f32_32x32x16_bf16 v[64:79], v[16:19], v[52:55], v[64:79]
    s_waitcnt lgkmcnt(0)
    v_mfma_f32_32x32x16_bf16 v[64:79], v[20:23], v[56:59], v[64:79]
    s_barrier
    ds_read_b128 v[52:55], v60 offset:0
    ds_read_b64_tr_b16 v[16:17], v40 offset:16384
    ds_read_b64_tr_b16 v[18:19], v40 offset:16896
    ds_read_b128 v[56:59], v60 offset:1024
    ds_read_b64_tr_b16 v[20:21], v40 offset:18432
    ds_read_b64_tr_b16 v[22:23], v40 offset:18944
    s_waitcnt lgkmcnt(3)
    v_mfma_f32_32x32x16_bf16 v[64:79], v[16:19], v[52:55], v[64:79]
    ds_read_b128 v[52:55], v60 offset:2048
    ds_read_b64_tr_b16 v[16:17], v40 offset:20480
    ds_read_b64_tr_b16 v[18:19], v40 offset:20992
    s_waitcnt lgkmcnt(3)
    v_mfma_f32_32x32x16_bf16 v[64:79], v[20:23], v[56:59], v[64:79]
    ds_read_b128 v[56:59], v60 offset:3072
    ds_read_b64_tr_b16 v[20:21], v40 offset:22528
    ds_read_b64_tr_b16 v[22:23], v40 offset:23040
    s_waitcnt lgkmcnt(3)
    v_mfma_f32_32x32x16_bf16 v[64:79], v[16:19], v[52:55], v[64:79]
    ds_read_b128 v[52:55], v60 offset:4096
    ds_read_b64_tr_b16 v[16:17], v40 offset:24576
    ds_read_b64_tr_b16 v[18:19], v40 offset:25088
    s_waitcnt lgkmcnt(3)
    v_mfma_f32_32x32x16_bf16 v[64:79], v[20:23], v[56:59], v[64:79]
    ds_read_b128 v[56:59], v60 offset:5120
    ds_read_b64_tr_b16 v[20:21], v40 offset:26624
    ds_read_b64_tr_b16 v[22:23], v40 offset:27136
    s_waitcnt lgkmcnt(3)
    v_mfma_f32_32x32x16_bf16 v[64:79], v[16:19], v[52:55], v[64:79]
    ds_read_b128 v[52:55], v60 offset:6144
    ds_read_b64_tr_b16 v[16:17], v40 offset:28672
    ds_read_b64_tr_b16 v[18:19], v40 offset:29184
    s_waitcnt lgkmcnt(3)
    v_mfma_f32_32x32x16_bf16 v[64:79], v[20:23], v[56:59], v[64:79]
    ds_read_b128 v[56:59], v60 offset:7168
    ds_read_b64_tr_b16 v[20:21], v40 offset:30720
    ds_read_b64_tr_b16 v[22:23], v40 offset:31232
    s_waitcnt lgkmcnt(3)
    v_mfma_f32_32x32x16_bf16 v[64:79], v[16:19], v[52:55], v[64:79]
    s_waitcnt lgkmcnt(0)
    v_mfma_f32_32x32x16_bf16 v[64:79], v[20:23], v[56:59], v[64:79]
    s_barrier
    ds_read_b128 v[52:55], v60 offset:32768
    ds_read_b64_tr_b16 v[16:17], v40 offset:49152
    ds_read_b64_tr_b16 v[18:19], v40 offset:49664
    ds_read_b128 v[56:59], v60 offset:33792
    ds_read_b64_tr_b16 v[20:21], v40 offset:51200
    ds_read_b64_tr_b16 v[22:23], v40 offset:51712
    s_waitcnt lgkmcnt(3)
    v_mfma_f32_32x32x16_bf16 v[64:79], v[16:19], v[52:55], v[64:79]
    ds_read_b128 v[52:55], v60 offset:34816
    ds_read_b64_tr_b16 v[16:17], v40 offset:53248
    ds_read_b64_tr_b16 v[18:19], v40 offset:53760
    s_waitcnt lgkmcnt(3)
    v_mfma_f32_32x32x16_bf16 v[64:79], v[20:23], v[56:59], v[64:79]
    ds_read_b128 v[56:59], v60 offset:35840
    ds_read_b64_tr_b16 v[20:21], v40 offset:55296
    ds_read_b64_tr_b16 v[22:23], v40 offset:55808
    s_waitcnt lgkmcnt(3)
    v_mfma_f32_32x32x16_bf16 v[64:79], v[16:19], v[52:55], v[64:79]
    ds_read_b128 v[52:55], v60 offset:36864
    ds_read_b64_tr_b16 v[16:17], v40 offset:57344
    ds_read_b64_tr_b16 v[18:19], v40 offset:57856
    s_waitcnt lgkmcnt(3)
    v_mfma_f32_32x32x16_bf16 v[64:79], v[20:23], v[56:59], v[64:79]
    ds_read_b128 v[56:59], v60 offset:37888
    ds_read_b64_tr_b16 v[20:21], v40 offset:59392
    ds_read_b64_tr_b16 v[22:23], v40 offset:59904
    s_waitcnt lgkmcnt(3)
    v_mfma_f32_32x32x16_bf16 v[64:79], v[16:19], v[52:55], v[64:79]
    ds_read_b128 v[52:55], v60 offset:38912
    ds_read_b64_tr_b16 v[16:17], v40 offset:61440
    ds_read_b64_tr_b16 v[18:19], v40 offset:61952
    s_waitcnt lgkmcnt(3)
    v_mfma_f32_32x32x16_bf16 v[64:79], v[20:23], v[56:59], v[64:79]
    ds_read_b128 v[56:59], v60 offset:39936
    ds_read_b64_tr_b16 v[20:21], v40 offset:63488
    ds_read_b64_tr_b16 v[22:23], v40 offset:64000
    s_waitcnt lgkmcnt(3)
    v_mfma_f32_32x32x16_bf16 v[64:79], v[16:19], v[52:55], v[64:79]
    s_waitcnt lgkmcnt(0)
    v_mfma_f32_32x32x16_bf16 v[64:79], v[20:23], v[56:59], v[64:79]
    s_barrier
    ds_read_b128 v[52:55], v61 offset:0
    ds_read_b64_tr_b16 v[16:17], v43 offset:16384
    ds_read_b64_tr_b16 v[18:19], v43 offset:16896
    ds_read_b128 v[56:59], v61 offset:1024
    ds_read_b64_tr_b16 v[20:21], v43 offset:18432
    ds_read_b64_tr_b16 v[22:23], v43 offset:18944
    s_waitcnt lgkmcnt(3)
    v_mfma_f32_32x32x16_bf16 v[64:79], v[16:19], v[52:55], v[64:79]
    ds_read_b128 v[52:55], v61 offset:2048
    ds_read_b64_tr_b16 v[16:17], v43 offset:20480
    ds_read_b64_tr_b16 v[18:19], v43 offset:20992
    s_waitcnt lgkmcnt(3)
    v_mfma_f32_32x32x16_bf16 v[64:79], v[20:23], v[56:59], v[64:79]
    ds_read_b128 v[56:59], v61 offset:3072
    ds_read_b64_tr_b16 v[20:21], v43 offset:22528
    ds_read_b64_tr_b16 v[22:23], v43 offset:23040
    s_waitcnt lgkmcnt(3)
    v_mfma_f32_32x32x16_bf16 v[64:79], v[16:19], v[52:55], v[64:79]
    ds_read_b128 v[52:55], v61 offset:4096
    ds_read_b64_tr_b16 v[16:17], v43 offset:24576
    ds_read_b64_tr_b16 v[18:19], v43 offset:25088
    s_waitcnt lgkmcnt(3)
    v_mfma_f32_32x32x16_bf16 v[64:79], v[20:23], v[56:59], v[64:79]
    ds_read_b128 v[56:59], v61 offset:5120
    ds_read_b64_tr_b16 v[20:21], v43 offset:26624
    ds_read_b64_tr_b16 v[22:23], v43 offset:27136
    s_waitcnt lgkmcnt(3)
    v_mfma_f32_32x32x16_bf16 v[64:79], v[16:19], v[52:55], v[64:79]
    ds_read_b128 v[52:55], v61 offset:6144
    ds_read_b64_tr_b16 v[16:17], v43 offset:28672
    ds_read_b64_tr_b16 v[18:19], v43 offset:29184
    s_waitcnt lgkmcnt(3)
    v_mfma_f32_32x32x16_bf16 v[64:79], v[20:23], v[56:59], v[64:79]
    ds_read_b128 v[56:59], v61 offset:7168
    ds_read_b64_tr_b16 v[20:21], v43 offset:30720
    ds_read_b64_tr_b16 v[22:23], v43 offset:31232
    s_waitcnt lgkmcnt(3)
    v_mfma_f32_32x32x16_bf16 v[64:79], v[16:19], v[52:55], v[64:79]
    s_waitcnt lgkmcnt(0)
    v_mfma_f32_32x32x16_bf16 v[64:79], v[20:23], v[56:59], v[64:79]
    s_barrier
    ds_read_b128 v[52:55], v61 offset:32768
    ds_read_b64_tr_b16 v[16:17], v43 offset:49152
    ds_read_b64_tr_b16 v[18:19], v43 offset:49664
    ds_read_b128 v[56:59], v61 offset:33792
    ds_read_b64_tr_b16 v[20:21], v43 offset:51200
    ds_read_b64_tr_b16 v[22:23], v43 offset:51712
    s_waitcnt lgkmcnt(3)
    v_mfma_f32_32x32x16_bf16 v[64:79], v[16:19], v[52:55], v[64:79]
    ds_read_b128 v[52:55], v61 offset:34816
    ds_read_b64_tr_b16 v[16:17], v43 offset:53248
    ds_read_b64_tr_b16 v[18:19], v43 offset:53760
    s_waitcnt lgkmcnt(3)
    v_mfma_f32_32x32x16_bf16 v[64:79], v[20:23], v[56:59], v[64:79]
    ds_read_b128 v[56:59], v61 offset:35840
    ds_read_b64_tr_b16 v[20:21], v43 offset:55296
    ds_read_b64_tr_b16 v[22:23], v43 offset:55808
    s_waitcnt lgkmcnt(3)
    v_mfma_f32_32x32x16_bf16 v[64:79], v[16:19], v[52:55], v[64:79]
    ds_read_b128 v[52:55], v61 offset:36864
    ds_read_b64_tr_b16 v[16:17], v43 offset:57344
    ds_read_b64_tr_b16 v[18:19], v43 offset:57856
    s_waitcnt lgkmcnt(3)
    v_mfma_f32_32x32x16_bf16 v[64:79], v[20:23], v[56:59], v[64:79]
    ds_read_b128 v[56:59], v61 offset:37888
    ds_read_b64_tr_b16 v[20:21], v43 offset:59392
    ds_read_b64_tr_b16 v[22:23], v43 offset:59904
    s_waitcnt lgkmcnt(3)
    v_mfma_f32_32x32x16_bf16 v[64:79], v[16:19], v[52:55], v[64:79]
    ds_read_b128 v[52:55], v61 offset:38912
    ds_read_b64_tr_b16 v[16:17], v43 offset:61440
    ds_read_b64_tr_b16 v[18:19], v43 offset:61952
    s_waitcnt lgkmcnt(3)
    v_mfma_f32_32x32x16_bf16 v[64:79], v[20:23], v[56:59], v[64:79]
    ds_read_b128 v[56:59], v61 offset:39936
    ds_read_b64_tr_b16 v[20:21], v43 offset:63488
    ds_read_b64_tr_b16 v[22:23], v43 offset:64000
    s_waitcnt lgkmcnt(3)
    v_mfma_f32_32x32x16_bf16 v[64:79], v[16:19], v[52:55], v[64:79]
    s_waitcnt lgkmcnt(0)
    v_mfma_f32_32x32x16_bf16 v[64:79], v[20:23], v[56:59], v[64:79]
    s_barrier
    ds_read_b128 v[52:55], v60 offset:0
    ds_read_b64_tr_b16 v[16:17], v40 offset:16384
    ds_read_b64_tr_b16 v[18:19], v40 offset:16896
    ds_read_b128 v[56:59], v60 offset:1024
    ds_read_b64_tr_b16 v[20:21], v40 offset:18432
    ds_read_b64_tr_b16 v[22:23], v40 offset:18944
    s_waitcnt lgkmcnt(3)
    v_mfma_f32_32x32x16_bf16 v[64:79], v[16:19], v[52:55], v[64:79]
    ds_read_b128 v[52:55], v60 offset:2048
    ds_read_b64_tr_b16 v[16:17], v40 offset:20480
    ds_read_b64_tr_b16 v[18:19], v40 offset:20992
    s_waitcnt lgkmcnt(3)
    v_mfma_f32_32x32x16_bf16 v[64:79], v[20:23], v[56:59], v[64:79]
    ds_read_b128 v[56:59], v60 offset:3072
    ds_read_b64_tr_b16 v[20:21], v40 offset:22528
    ds_read_b64_tr_b16 v[22:23], v40 offset:23040
    s_waitcnt lgkmcnt(3)
    v_mfma_f32_32x32x16_bf16 v[64:79], v[16:19], v[52:55], v[64:79]
    ds_read_b128 v[52:55], v60 offset:4096
    ds_read_b64_tr_b16 v[16:17], v40 offset:24576
    ds_read_b64_tr_b16 v[18:19], v40 offset:25088
    s_waitcnt lgkmcnt(3)
    v_mfma_f32_32x32x16_bf16 v[64:79], v[20:23], v[56:59], v[64:79]
    ds_read_b128 v[56:59], v60 offset:5120
    ds_read_b64_tr_b16 v[20:21], v40 offset:26624
    ds_read_b64_tr_b16 v[22:23], v40 offset:27136
    s_waitcnt lgkmcnt(3)
    v_mfma_f32_32x32x16_bf16 v[64:79], v[16:19], v[52:55], v[64:79]
    ds_read_b128 v[52:55], v60 offset:6144
    ds_read_b64_tr_b16 v[16:17], v40 offset:28672
    ds_read_b64_tr_b16 v[18:19], v40 offset:29184
    s_waitcnt lgkmcnt(3)
    v_mfma_f32_32x32x16_bf16 v[64:79], v[20:23], v[56:59], v[64:79]
    ds_read_b128 v[56:59], v60 offset:7168
    ds_read_b64_tr_b16 v[20:21], v40 offset:30720
    ds_read_b64_tr_b16 v[22:23], v40 offset:31232
    s_waitcnt lgkmcnt(3)
    v_mfma_f32_32x32x16_bf16 v[64:79], v[16:19], v[52:55], v[64:79]
    s_waitcnt lgkmcnt(0)
    v_mfma_f32_32x32x16_bf16 v[64:79], v[20:23], v[56:59], v[64:79]
    s_barrier
    ds_read_b128 v[52:55], v60 offset:32768
    ds_read_b64_tr_b16 v[16:17], v40 offset:49152
    ds_read_b64_tr_b16 v[18:19], v40 offset:49664
    ds_read_b128 v[56:59], v60 offset:33792
    ds_read_b64_tr_b16 v[20:21], v40 offset:51200
    ds_read_b64_tr_b16 v[22:23], v40 offset:51712
    s_waitcnt lgkmcnt(3)
    v_mfma_f32_32x32x16_bf16 v[64:79], v[16:19], v[52:55], v[64:79]
    ds_read_b128 v[52:55], v60 offset:34816
    ds_read_b64_tr_b16 v[16:17], v40 offset:53248
    ds_read_b64_tr_b16 v[18:19], v40 offset:53760
    s_waitcnt lgkmcnt(3)
    v_mfma_f32_32x32x16_bf16 v[64:79], v[20:23], v[56:59], v[64:79]
    ds_read_b128 v[56:59], v60 offset:35840
    ds_read_b64_tr_b16 v[20:21], v40 offset:55296
    ds_read_b64_tr_b16 v[22:23], v40 offset:55808
    s_waitcnt lgkmcnt(3)
    v_mfma_f32_32x32x16_bf16 v[64:79], v[16:19], v[52:55], v[64:79]
    ds_read_b128 v[52:55], v60 offset:36864
    ds_read_b64_tr_b16 v[16:17], v40 offset:57344
    ds_read_b64_tr_b16 v[18:19], v40 offset:57856
    s_waitcnt lgkmcnt(3)
    v_mfma_f32_32x32x16_bf16 v[64:79], v[20:23], v[56:59], v[64:79]
    ds_read_b128 v[56:59], v60 offset:37888
    ds_read_b64_tr_b16 v[20:21], v40 offset:59392
    ds_read_b64_tr_b16 v[22:23], v40 offset:59904
    s_waitcnt lgkmcnt(3)
    v_mfma_f32_32x32x16_bf16 v[64:79], v[16:19], v[52:55], v[64:79]
    ds_read_b128 v[52:55], v60 offset:38912
    ds_read_b64_tr_b16 v[16:17], v40 offset:61440
    ds_read_b64_tr_b16 v[18:19], v40 offset:61952
    s_waitcnt lgkmcnt(3)
    v_mfma_f32_32x32x16_bf16 v[64:79], v[20:23], v[56:59], v[64:79]
    ds_read_b128 v[56:59], v60 offset:39936
    ds_read_b64_tr_b16 v[20:21], v40 offset:63488
    ds_read_b64_tr_b16 v[22:23], v40 offset:64000
    s_waitcnt lgkmcnt(3)
    v_mfma_f32_32x32x16_bf16 v[64:79], v[16:19], v[52:55], v[64:79]
    s_waitcnt lgkmcnt(0)
    v_mfma_f32_32x32x16_bf16 v[64:79], v[20:23], v[56:59], v[64:79]
    s_barrier
    ds_read_b128 v[52:55], v61 offset:0
    ds_read_b64_tr_b16 v[16:17], v43 offset:16384
    ds_read_b64_tr_b16 v[18:19], v43 offset:16896
    ds_read_b128 v[56:59], v61 offset:1024
    ds_read_b64_tr_b16 v[20:21], v43 offset:18432
    ds_read_b64_tr_b16 v[22:23], v43 offset:18944
    s_waitcnt lgkmcnt(3)
    v_mfma_f32_32x32x16_bf16 v[64:79], v[16:19], v[52:55], v[64:79]
    ds_read_b128 v[52:55], v61 offset:2048
    ds_read_b64_tr_b16 v[16:17], v43 offset:20480
    ds_read_b64_tr_b16 v[18:19], v43 offset:20992
    s_waitcnt lgkmcnt(3)
    v_mfma_f32_32x32x16_bf16 v[64:79], v[20:23], v[56:59], v[64:79]
    ds_read_b128 v[56:59], v61 offset:3072
    ds_read_b64_tr_b16 v[20:21], v43 offset:22528
    ds_read_b64_tr_b16 v[22:23], v43 offset:23040
    s_waitcnt lgkmcnt(3)
    v_mfma_f32_32x32x16_bf16 v[64:79], v[16:19], v[52:55], v[64:79]
    ds_read_b128 v[52:55], v61 offset:4096
    ds_read_b64_tr_b16 v[16:17], v43 offset:24576
    ds_read_b64_tr_b16 v[18:19], v43 offset:25088
    s_waitcnt lgkmcnt(3)
    v_mfma_f32_32x32x16_bf16 v[64:79], v[20:23], v[56:59], v[64:79]
    ds_read_b128 v[56:59], v61 offset:5120
    ds_read_b64_tr_b16 v[20:21], v43 offset:26624
    ds_read_b64_tr_b16 v[22:23], v43 offset:27136
    s_waitcnt lgkmcnt(3)
    v_mfma_f32_32x32x16_bf16 v[64:79], v[16:19], v[52:55], v[64:79]
    s_waitcnt lgkmcnt(0)
    v_mfma_f32_32x32x16_bf16 v[64:79], v[20:23], v[56:59], v[64:79]
    s_nop 15
    v_cvt_pk_bf16_f32 v64, v64, v65
    v_cvt_pk_bf16_f32 v65, v66, v67
    v_cvt_pk_bf16_f32 v66, v68, v69
    v_cvt_pk_bf16_f32 v67, v70, v71
    v_cvt_pk_bf16_f32 v68, v72, v73
    v_cvt_pk_bf16_f32 v69, v74, v75
    v_cvt_pk_bf16_f32 v70, v76, v77
    v_cvt_pk_bf16_f32 v71, v78, v79
    s_nop 1
    v_permlane32_swap_b32 v64, v66
    v_permlane32_swap_b32 v65, v67
    v_permlane32_swap_b32 v68, v70
    v_permlane32_swap_b32 v69, v71
    s_nop 1
    s_waitcnt vmcnt(0)
    v_lshlrev_b32 v9, 16, v64
    v_and_b32 v10, 0xffff0000, v64
    v_lshlrev_b32 v11, 16, v112
    v_and_b32 v12, 0xffff0000, v112
    v_add_f32 v9, v9, v11
    v_add_f32 v10, v10, v12
    v_cvt_pk_bf16_f32 v64, v9, v10
    v_lshlrev_b32 v9, 16, v65
    v_and_b32 v10, 0xffff0000, v65
    v_lshlrev_b32 v11, 16, v113
    v_and_b32 v12, 0xffff0000, v113
    v_add_f32 v9, v9, v11
    v_add_f32 v10, v10, v12
    v_cvt_pk_bf16_f32 v65, v9, v10
    v_lshlrev_b32 v9, 16, v66
    v_and_b32 v10, 0xffff0000, v66
    v_lshlrev_b32 v11, 16, v114
    v_and_b32 v12, 0xffff0000, v114
    v_add_f32 v9, v9, v11
    v_add_f32 v10, v10, v12
    v_cvt_pk_bf16_f32 v66, v9, v10
    v_lshlrev_b32 v9, 16, v67
    v_and_b32 v10, 0xffff0000, v67
    v_lshlrev_b32 v11, 16, v115
    v_and_b32 v12, 0xffff0000, v115
    v_add_f32 v9, v9, v11
    v_add_f32 v10, v10, v12
    v_cvt_pk_bf16_f32 v67, v9, v10
    v_lshlrev_b32 v9, 16, v68
    v_and_b32 v10, 0xffff0000, v68
    v_lshlrev_b32 v11, 16, v116
    v_and_b32 v12, 0xffff0000, v116
    v_add_f32 v9, v9, v11
    v_add_f32 v10, v10, v12
    v_cvt_pk_bf16_f32 v68, v9, v10
    v_lshlrev_b32 v9, 16, v69
    v_and_b32 v10, 0xffff0000, v69
    v_lshlrev_b32 v11, 16, v117
    v_and_b32 v12, 0xffff0000, v117
    v_add_f32 v9, v9, v11
    v_add_f32 v10, v10, v12
    v_cvt_pk_bf16_f32 v69, v9, v10
    v_lshlrev_b32 v9, 16, v70
    v_and_b32 v10, 0xffff0000, v70
    v_lshlrev_b32 v11, 16, v118
    v_and_b32 v12, 0xffff0000, v118
    v_add_f32 v9, v9, v11
    v_add_f32 v10, v10, v12
    v_cvt_pk_bf16_f32 v70, v9, v10
    v_lshlrev_b32 v9, 16, v71
    v_and_b32 v10, 0xffff0000, v71
    v_lshlrev_b32 v11, 16, v119
    v_and_b32 v12, 0xffff0000, v119
    v_add_f32 v9, v9, v11
    v_add_f32 v10, v10, v12
    v_cvt_pk_bf16_f32 v71, v9, v10
    buffer_store_dwordx4 v[64:67], v47, s[32:35], 0 offen
    buffer_store_dwordx4 v[68:71], v47, s[32:35], 0 offen offset:32
    s_waitcnt vmcnt(0)
L_kw2_kernel_end:
    s_endpgm
.section .rodata,"a"
.p2align 6
.amdhsa_kernel kqkv_kernel
  .amdhsa_next_free_vgpr 160
  .amdhsa_next_free_sgpr 100
  .amdhsa_accum_offset 160
  .amdhsa_group_segment_fixed_size 0
  .amdhsa_kernarg_size 72
  .amdhsa_user_sgpr_count 2
  .amdhsa_user_sgpr_kernarg_segment_ptr 1
  .amdhsa_system_sgpr_workgroup_id_x 1
.end_amdhsa_kernel
.p2align 6
.amdhsa_kernel kattn_kernel
  .amdhsa_next_free_vgpr 256
  .amdhsa_next_free_sgpr 100
  .amdhsa_accum_offset 256
  .amdhsa_group_segment_fixed_size 0
  .amdhsa_kernarg_size 72
  .amdhsa_user_sgpr_count 2
  .amdhsa_user_sgpr_kernarg_segment_ptr 1
  .amdhsa_system_sgpr_workgroup_id_x 1
.end_amdhsa_kernel
.p2align 6
.amdhsa_kernel kwo_kernel
  .amdhsa_next_free_vgpr 160
  .amdhsa_next_free_sgpr 100
  .amdhsa_accum_offset 160
  .amdhsa_group_segment_fixed_size 0
  .amdhsa_kernarg_size 72
  .amdhsa_user_sgpr_count 2
  .amdhsa_user_sgpr_kernarg_segment_ptr 1
  .amdhsa_system_sgpr_workgroup_id_x 1
.end_amdhsa_kernel
.p2align 6
.amdhsa_kernel kw1_kernel
  .amdhsa_next_free_vgpr 160
  .amdhsa_next_free_sgpr 100
  .amdhsa_accum_offset 160
  .amdhsa_group_segment_fixed_size 0
  .amdhsa_kernarg_size 72
  .amdhsa_user_sgpr_count 2
  .amdhsa_user_sgpr_kernarg_segment_ptr 1
  .amdhsa_system_sgpr_workgroup_id_x 1
.end_amdhsa_kernel
.p2align 6
.amdhsa_kernel kw2_kernel
  .amdhsa_next_free_vgpr 160
  .amdhsa_next_free_sgpr 100
  .amdhsa_accum_offset 160
  .amdhsa_group_segment_fixed_size 0
  .amdhsa_kernarg_size 72
  .amdhsa_user_sgpr_count 2
  .amdhsa_user_sgpr_kernarg_segment_ptr 1
  .amdhsa_system_sgpr_workgroup_id_x 1
.end_amdhsa_kernel
```
